```python
import torch

def _softmax(x, axis=-1):
    return torch.softmax(x, dim=axis)
def _gelu(x):
    return torch.nn.functional.gelu(x, approximate="tanh")
def _silu(x):
    return torch.nn.functional.silu(x)
def _sigmoid(x):
    return torch.sigmoid(x)
def _layernorm(x, axis=-1, eps=1e-5):
    m = x.mean(dim=axis, keepdim=True)
    v = x.var(dim=axis, keepdim=True, unbiased=False)
    return (x - m) / torch.sqrt(v + eps)
def _scatter_add(tgt, idx, src, axis=0):
    return tgt.clone().index_add_(axis, idx, src)
def _segment_sum(src, seg, n):
    out = torch.zeros((n,) + src.shape[1:], dtype=src.dtype)
    return out.index_add_(0, seg, src)
def _pad(x, pw):
    flat = tuple(v for pair in reversed(pw) for v in pair)
    return torch.nn.functional.pad(x, flat)

kernel_name = 'concat_heads__gqa_block_cached__mha_block_cached__near_ridge'

def setup_inputs():

    _w = (lambda a: (lambda t: t.to(torch.bfloat16) if t.is_floating_point() else t)(torch.as_tensor(a)))
    def _A_setup():
        B, Sq, D = 16, 48, 512
        Hq, Hkv, Sk, Dh = 32, 8, 1024, 128
        assert Hq % Hkv == 0, (Hq, Hkv)
        return {
            "x": _w((lambda *s: torch.randn(*s, dtype=torch.bfloat16) * 0.8)(B, Sq, D)),
            "k_cache": _w((lambda *s: torch.randn(*s, dtype=torch.bfloat16) * 0.8)(B, Hkv, Sk, Dh)),
            "v_cache": _w((lambda *s: torch.randn(*s, dtype=torch.bfloat16) * 0.05)(B, Hkv, Sk, Dh)),
            "wq": _w((lambda *s: torch.randn(*s, dtype=torch.bfloat16) * 0.8)(D, Hq * Dh) * (D ** -0.5)),
            "wo": _w((lambda *s: torch.randn(*s, dtype=torch.bfloat16) * 0.05)(Hq * Dh, D) * ((Hq * Dh) ** -0.5)),
        }
    _A_in = _A_setup()

    def _B_setup():
        B, Sq, D = 16, 48, 512
        H, Sk, Dh = 32, 1024, 128
        return {
            "x": _w((lambda *s: torch.randn(*s, dtype=torch.bfloat16) * 0.8)(B, Sq, D)),
            "k_cache": _w((lambda *s: torch.randn(*s, dtype=torch.bfloat16) * 0.8)(B, H, Sk, Dh)),
            "v_cache": _w((lambda *s: torch.randn(*s, dtype=torch.bfloat16) * 0.05)(B, H, Sk, Dh)),
            "wq": _w((lambda *s: torch.randn(*s, dtype=torch.bfloat16) * 0.8)(D, H * Dh) * (D ** -0.5)),
            "wo": _w((lambda *s: torch.randn(*s, dtype=torch.bfloat16) * 0.05)(H * Dh, D) * ((H * Dh) ** -0.5)),
        }
    _B_in = _B_setup()

    return {
        "A_x": _A_in["x"],
        "A_k_cache": _A_in["k_cache"],
        "A_v_cache": _A_in["v_cache"],
        "A_wq": _A_in["wq"],
        "A_wo": _A_in["wo"],
        "B_x": _B_in["x"],
        "B_k_cache": _B_in["k_cache"],
        "B_v_cache": _B_in["v_cache"],
        "B_wq": _B_in["wq"],
        "B_wo": _B_in["wo"],
    }

def reference(A_x, A_k_cache, A_v_cache, A_wq, A_wo, B_x, B_k_cache, B_v_cache, B_wq, B_wo):
    def _A_ref(x, k_cache, v_cache, wq, wo):
        B, Sq, D = x.shape
        Hq, Dh = 32, 128
        Hkv = k_cache.shape[1]
        rep = Hq // Hkv
        q = (lambda x, *d: x.permute(*d))((x @ wq).reshape(B, Sq, Hq, Dh), 0, 2, 1, 3)
        k = (lambda x, n, axis: torch.repeat_interleave(x, n, dim=axis))(k_cache, rep, axis=1)
        v = (lambda x, n, axis: torch.repeat_interleave(x, n, dim=axis))(v_cache, rep, axis=1)
        scores = torch.einsum("bhqd,bhkd->bhqk", q, k) * (Dh ** -0.5)
        p = _softmax(scores, axis=-1)
        o = torch.einsum("bhqk,bhkd->bhqd", p, v)
        return (lambda x, *d: x.permute(*d))(o, 0, 2, 1, 3).reshape(B, Sq, Hq * Dh) @ wo

    def _B_ref(x, k_cache, v_cache, wq, wo):
        B, Sq, D = x.shape
        H, Dh = 32, 128
        q = (lambda x, *d: x.permute(*d))((x @ wq).reshape(B, Sq, H, Dh), 0, 2, 1, 3)
        scores = torch.einsum("bhqd,bhkd->bhqk", q, k_cache) * (Dh ** -0.5)
        p = _softmax(scores, axis=-1)
        o = torch.einsum("bhqk,bhkd->bhqd", p, v_cache)
        return (lambda x, *d: x.permute(*d))(o, 0, 2, 1, 3).reshape(B, Sq, H * Dh) @ wo

    a = _A_ref(A_x, A_k_cache, A_v_cache, A_wq, A_wo)
    b = _B_ref(B_x, B_k_cache, B_v_cache, B_wq, B_wo)
    return torch.concatenate([a, b], axis=-1)
```

```asm
; @launch grid=(256,1,1) block=(512,1,1) lds=148480
.amdgcn_target "amdgcn-amd-amdhsa--gfx950"
.text
.globl concat_heads__gqa_block_cached__mha_block_cached__near_ridge_kernel
.p2align 8
.type concat_heads__gqa_block_cached__mha_block_cached__near_ridge_kernel,@function
concat_heads__gqa_block_cached__mha_block_cached__near_ridge_kernel:
    s_cmp_ge_u32 s2, 256
    s_cbranch_scc1 K_end
    s_load_dwordx8 s[4:11], s[0:1], 0
    s_load_dwordx8 s[72:79], s[0:1], 40
    s_load_dwordx2 s[12:13], s[0:1], 32
    s_load_dwordx4 s[16:19], s[0:1], 80
    s_load_dwordx2 s[80:81], s[0:1], 72
    s_load_dwordx2 s[20:21], s[0:1], 96
    v_lshrrev_b32 v1, 6, v0
    v_and_b32 v0, 63, v0
    v_readfirstlane_b32 s22, v1
    v_lshlrev_b32 v1, 4, v0
    v_mov_b32 v2, 0
    v_mov_b32 v4, 1
    v_lshlrev_b32 v3, 2, v0
    ds_write_b32 v3, v2
    s_and_b32 s23, s2, 7
    s_lshr_b32 s24, s2, 3
    s_lshr_b32 s26, s24, 1
    s_and_b32 s27, s24, 1
    s_lshl_b32 s29, s23, 2
    s_lshl_b32 s30, s27, 1
    s_add_u32 s29, s29, s30
    s_and_b32 s25, s22, 3
    s_lshr_b32 s28, s24, 2
    s_lshl_b32 s28, s28, 1
    s_and_b32 s67, s24, 3
    s_lshl_b32 s30, s23, 2
    s_add_u32 s67, s67, s30
    s_waitcnt lgkmcnt(0)
    s_barrier
    s_cmp_lt_u32 s22, 4
    s_cbranch_scc1 R_att
    s_branch R_gemm
S_w:
    s_mov_b32 s82, 0
    buffer_load_dwordx4 v[108:111], v5, s[48:51], s82 offen
    s_add_u32 s82, s82, s83
    buffer_load_dwordx4 v[112:115], v5, s[48:51], s82 offen
    s_add_u32 s82, s82, s83
    buffer_load_dwordx4 v[116:119], v5, s[48:51], s82 offen
    s_add_u32 s82, s82, s83
    buffer_load_dwordx4 v[120:123], v5, s[48:51], s82 offen
    s_add_u32 s82, s82, s84
    buffer_load_dwordx4 v[124:127], v5, s[48:51], s82 offen
    s_add_u32 s82, s82, s83
    buffer_load_dwordx4 v[128:131], v5, s[48:51], s82 offen
    s_add_u32 s82, s82, s83
    buffer_load_dwordx4 v[132:135], v5, s[48:51], s82 offen
    s_add_u32 s82, s82, s83
    buffer_load_dwordx4 v[136:139], v5, s[48:51], s82 offen
    s_add_u32 s82, s82, s85
    buffer_load_dwordx4 v[140:143], v5, s[48:51], s82 offen
    s_add_u32 s82, s82, s83
    buffer_load_dwordx4 v[144:147], v5, s[48:51], s82 offen
    s_add_u32 s82, s82, s83
    buffer_load_dwordx4 v[148:151], v5, s[48:51], s82 offen
    s_add_u32 s82, s82, s83
    buffer_load_dwordx4 v[152:155], v5, s[48:51], s82 offen
    s_add_u32 s82, s82, s84
    buffer_load_dwordx4 v[156:159], v5, s[48:51], s82 offen
    s_add_u32 s82, s82, s83
    buffer_load_dwordx4 v[160:163], v5, s[48:51], s82 offen
    s_add_u32 s82, s82, s83
    buffer_load_dwordx4 v[164:167], v5, s[48:51], s82 offen
    s_add_u32 s82, s82, s83
    buffer_load_dwordx4 v[168:171], v5, s[48:51], s82 offen
    s_add_u32 s82, s82, s85
    buffer_load_dwordx4 v[172:175], v5, s[48:51], s82 offen
    s_add_u32 s82, s82, s83
    buffer_load_dwordx4 v[176:179], v5, s[48:51], s82 offen
    s_add_u32 s82, s82, s83
    buffer_load_dwordx4 v[180:183], v5, s[48:51], s82 offen
    s_add_u32 s82, s82, s83
    buffer_load_dwordx4 v[184:187], v5, s[48:51], s82 offen
    s_add_u32 s82, s82, s84
    buffer_load_dwordx4 v[188:191], v5, s[48:51], s82 offen
    s_add_u32 s82, s82, s83
    buffer_load_dwordx4 v[192:195], v5, s[48:51], s82 offen
    s_add_u32 s82, s82, s83
    buffer_load_dwordx4 v[196:199], v5, s[48:51], s82 offen
    s_add_u32 s82, s82, s83
    buffer_load_dwordx4 v[200:203], v5, s[48:51], s82 offen
    s_add_u32 s82, s82, s85
    buffer_load_dwordx4 v[204:207], v5, s[48:51], s82 offen
    s_add_u32 s82, s82, s83
    buffer_load_dwordx4 v[208:211], v5, s[48:51], s82 offen
    s_add_u32 s82, s82, s83
    buffer_load_dwordx4 v[212:215], v5, s[48:51], s82 offen
    s_add_u32 s82, s82, s83
    buffer_load_dwordx4 v[216:219], v5, s[48:51], s82 offen
    s_add_u32 s82, s82, s84
    buffer_load_dwordx4 v[220:223], v5, s[48:51], s82 offen
    s_add_u32 s82, s82, s83
    buffer_load_dwordx4 v[224:227], v5, s[48:51], s82 offen
    s_add_u32 s82, s82, s83
    buffer_load_dwordx4 v[228:231], v5, s[48:51], s82 offen
    s_add_u32 s82, s82, s83
    buffer_load_dwordx4 v[232:235], v5, s[48:51], s82 offen
    s_add_u32 s82, s82, s85
    s_setpc_b64 s[38:39]
S_g:
    v_mov_b32 v0, s87
G_w0:
    ds_read_b32 v3, v0
    s_waitcnt lgkmcnt(0)
    v_readfirstlane_b32 s31, v3
    s_cmp_ge_u32 s31, s89
    s_cbranch_scc1 G_w0_e
    s_sleep 2
    s_branch G_w0
G_w0_e:
    ds_read_b128 v[236:239], v8 offset:0
    ds_read_b128 v[240:243], v8 offset:4096
    ds_read_b128 v[244:247], v8 offset:8192
    v_add_u32 v8, s86, v8
    s_waitcnt vmcnt(24)
    v_perm_b32 v248, v112, v108, s52
    v_perm_b32 v249, v120, v116, s52
    v_perm_b32 v250, v128, v124, s52
    v_perm_b32 v251, v136, v132, s52
    s_waitcnt lgkmcnt(0)
    s_nop 0
    v_mfma_f32_16x16x32_bf16 v[12:15], v[248:251], v[236:239], 0
    v_perm_b32 v252, v112, v108, s53
    v_perm_b32 v253, v120, v116, s53
    v_mfma_f32_16x16x32_bf16 v[16:19], v[248:251], v[240:243], 0
    v_perm_b32 v254, v128, v124, s53
    v_perm_b32 v255, v136, v132, s53
    v_mfma_f32_16x16x32_bf16 v[20:23], v[248:251], v[244:247], 0
    s_nop 0
    v_mfma_f32_16x16x32_bf16 v[24:27], v[252:255], v[236:239], 0
    v_perm_b32 v248, v113, v109, s52
    v_perm_b32 v249, v121, v117, s52
    v_mfma_f32_16x16x32_bf16 v[28:31], v[252:255], v[240:243], 0
    v_perm_b32 v250, v129, v125, s52
    v_perm_b32 v251, v137, v133, s52
    v_mfma_f32_16x16x32_bf16 v[32:35], v[252:255], v[244:247], 0
    s_nop 0
    v_mfma_f32_16x16x32_bf16 v[36:39], v[248:251], v[236:239], 0
    v_perm_b32 v252, v113, v109, s53
    v_perm_b32 v253, v121, v117, s53
    v_mfma_f32_16x16x32_bf16 v[40:43], v[248:251], v[240:243], 0
    v_perm_b32 v254, v129, v125, s53
    v_perm_b32 v255, v137, v133, s53
    v_mfma_f32_16x16x32_bf16 v[44:47], v[248:251], v[244:247], 0
    s_nop 0
    v_mfma_f32_16x16x32_bf16 v[48:51], v[252:255], v[236:239], 0
    v_perm_b32 v248, v114, v110, s52
    v_perm_b32 v249, v122, v118, s52
    v_mfma_f32_16x16x32_bf16 v[52:55], v[252:255], v[240:243], 0
    v_perm_b32 v250, v130, v126, s52
    v_perm_b32 v251, v138, v134, s52
    v_mfma_f32_16x16x32_bf16 v[56:59], v[252:255], v[244:247], 0
    s_nop 0
    v_mfma_f32_16x16x32_bf16 v[60:63], v[248:251], v[236:239], 0
    v_perm_b32 v252, v114, v110, s53
    v_perm_b32 v253, v122, v118, s53
    v_mfma_f32_16x16x32_bf16 v[64:67], v[248:251], v[240:243], 0
    v_perm_b32 v254, v130, v126, s53
    v_perm_b32 v255, v138, v134, s53
    v_mfma_f32_16x16x32_bf16 v[68:71], v[248:251], v[244:247], 0
    s_nop 0
    v_mfma_f32_16x16x32_bf16 v[72:75], v[252:255], v[236:239], 0
    v_perm_b32 v248, v115, v111, s52
    v_perm_b32 v249, v123, v119, s52
    v_mfma_f32_16x16x32_bf16 v[76:79], v[252:255], v[240:243], 0
    v_perm_b32 v250, v131, v127, s52
    v_perm_b32 v251, v139, v135, s52
    v_mfma_f32_16x16x32_bf16 v[80:83], v[252:255], v[244:247], 0
    s_nop 0
    v_mfma_f32_16x16x32_bf16 v[84:87], v[248:251], v[236:239], 0
    v_perm_b32 v252, v115, v111, s53
    v_perm_b32 v253, v123, v119, s53
    v_mfma_f32_16x16x32_bf16 v[88:91], v[248:251], v[240:243], 0
    v_perm_b32 v254, v131, v127, s53
    v_perm_b32 v255, v139, v135, s53
    v_mfma_f32_16x16x32_bf16 v[92:95], v[248:251], v[244:247], 0
    s_nop 0
    v_mfma_f32_16x16x32_bf16 v[96:99], v[252:255], v[236:239], 0
    v_mfma_f32_16x16x32_bf16 v[100:103], v[252:255], v[240:243], 0
    v_mfma_f32_16x16x32_bf16 v[104:107], v[252:255], v[244:247], 0
    ds_read_b128 v[236:239], v9 offset:0
    ds_read_b128 v[240:243], v9 offset:4096
    ds_read_b128 v[244:247], v9 offset:8192
    v_add_u32 v9, s86, v9
    s_waitcnt vmcnt(16)
    v_perm_b32 v248, v144, v140, s52
    v_perm_b32 v249, v152, v148, s52
    v_perm_b32 v250, v160, v156, s52
    v_perm_b32 v251, v168, v164, s52
    s_waitcnt lgkmcnt(0)
    s_nop 0
    v_mfma_f32_16x16x32_bf16 v[12:15], v[248:251], v[236:239], v[12:15]
    v_perm_b32 v252, v144, v140, s53
    v_perm_b32 v253, v152, v148, s53
    v_mfma_f32_16x16x32_bf16 v[16:19], v[248:251], v[240:243], v[16:19]
    v_perm_b32 v254, v160, v156, s53
    v_perm_b32 v255, v168, v164, s53
    v_mfma_f32_16x16x32_bf16 v[20:23], v[248:251], v[244:247], v[20:23]
    buffer_load_dwordx4 v[108:111], v5, s[48:51], s82 offen
    s_add_u32 s82, s82, s83
    v_mfma_f32_16x16x32_bf16 v[24:27], v[252:255], v[236:239], v[24:27]
    v_perm_b32 v248, v145, v141, s52
    v_perm_b32 v249, v153, v149, s52
    v_mfma_f32_16x16x32_bf16 v[28:31], v[252:255], v[240:243], v[28:31]
    v_perm_b32 v250, v161, v157, s52
    v_perm_b32 v251, v169, v165, s52
    v_mfma_f32_16x16x32_bf16 v[32:35], v[252:255], v[244:247], v[32:35]
    buffer_load_dwordx4 v[112:115], v5, s[48:51], s82 offen
    s_add_u32 s82, s82, s83
    v_mfma_f32_16x16x32_bf16 v[36:39], v[248:251], v[236:239], v[36:39]
    v_perm_b32 v252, v145, v141, s53
    v_perm_b32 v253, v153, v149, s53
    v_mfma_f32_16x16x32_bf16 v[40:43], v[248:251], v[240:243], v[40:43]
    v_perm_b32 v254, v161, v157, s53
    v_perm_b32 v255, v169, v165, s53
    v_mfma_f32_16x16x32_bf16 v[44:47], v[248:251], v[244:247], v[44:47]
    buffer_load_dwordx4 v[116:119], v5, s[48:51], s82 offen
    s_add_u32 s82, s82, s83
    v_mfma_f32_16x16x32_bf16 v[48:51], v[252:255], v[236:239], v[48:51]
    v_perm_b32 v248, v146, v142, s52
    v_perm_b32 v249, v154, v150, s52
    v_mfma_f32_16x16x32_bf16 v[52:55], v[252:255], v[240:243], v[52:55]
    v_perm_b32 v250, v162, v158, s52
    v_perm_b32 v251, v170, v166, s52
    v_mfma_f32_16x16x32_bf16 v[56:59], v[252:255], v[244:247], v[56:59]
    buffer_load_dwordx4 v[120:123], v5, s[48:51], s82 offen
    s_add_u32 s82, s82, s84
    v_mfma_f32_16x16x32_bf16 v[60:63], v[248:251], v[236:239], v[60:63]
    v_perm_b32 v252, v146, v142, s53
    v_perm_b32 v253, v154, v150, s53
    v_mfma_f32_16x16x32_bf16 v[64:67], v[248:251], v[240:243], v[64:67]
    v_perm_b32 v254, v162, v158, s53
    v_perm_b32 v255, v170, v166, s53
    v_mfma_f32_16x16x32_bf16 v[68:71], v[248:251], v[244:247], v[68:71]
    buffer_load_dwordx4 v[124:127], v5, s[48:51], s82 offen
    s_add_u32 s82, s82, s83
    v_mfma_f32_16x16x32_bf16 v[72:75], v[252:255], v[236:239], v[72:75]
    v_perm_b32 v248, v147, v143, s52
    v_perm_b32 v249, v155, v151, s52
    v_mfma_f32_16x16x32_bf16 v[76:79], v[252:255], v[240:243], v[76:79]
    v_perm_b32 v250, v163, v159, s52
    v_perm_b32 v251, v171, v167, s52
    v_mfma_f32_16x16x32_bf16 v[80:83], v[252:255], v[244:247], v[80:83]
    buffer_load_dwordx4 v[128:131], v5, s[48:51], s82 offen
    s_add_u32 s82, s82, s83
    v_mfma_f32_16x16x32_bf16 v[84:87], v[248:251], v[236:239], v[84:87]
    v_perm_b32 v252, v147, v143, s53
    v_perm_b32 v253, v155, v151, s53
    v_mfma_f32_16x16x32_bf16 v[88:91], v[248:251], v[240:243], v[88:91]
    v_perm_b32 v254, v163, v159, s53
    v_perm_b32 v255, v171, v167, s53
    v_mfma_f32_16x16x32_bf16 v[92:95], v[248:251], v[244:247], v[92:95]
    buffer_load_dwordx4 v[132:135], v5, s[48:51], s82 offen
    s_add_u32 s82, s82, s83
    v_mfma_f32_16x16x32_bf16 v[96:99], v[252:255], v[236:239], v[96:99]
    v_mfma_f32_16x16x32_bf16 v[100:103], v[252:255], v[240:243], v[100:103]
    v_mfma_f32_16x16x32_bf16 v[104:107], v[252:255], v[244:247], v[104:107]
    buffer_load_dwordx4 v[136:139], v5, s[48:51], s82 offen
    s_add_u32 s82, s82, s85
    ds_read_b128 v[236:239], v10 offset:0
    ds_read_b128 v[240:243], v10 offset:4096
    ds_read_b128 v[244:247], v10 offset:8192
    v_add_u32 v10, s86, v10
    s_waitcnt vmcnt(16)
    v_perm_b32 v248, v176, v172, s52
    v_perm_b32 v249, v184, v180, s52
    v_perm_b32 v250, v192, v188, s52
    v_perm_b32 v251, v200, v196, s52
    s_waitcnt lgkmcnt(0)
    s_nop 0
    v_mfma_f32_16x16x32_bf16 v[12:15], v[248:251], v[236:239], v[12:15]
    v_perm_b32 v252, v176, v172, s53
    v_perm_b32 v253, v184, v180, s53
    v_mfma_f32_16x16x32_bf16 v[16:19], v[248:251], v[240:243], v[16:19]
    v_perm_b32 v254, v192, v188, s53
    v_perm_b32 v255, v200, v196, s53
    v_mfma_f32_16x16x32_bf16 v[20:23], v[248:251], v[244:247], v[20:23]
    buffer_load_dwordx4 v[140:143], v5, s[48:51], s82 offen
    s_add_u32 s82, s82, s83
    v_mfma_f32_16x16x32_bf16 v[24:27], v[252:255], v[236:239], v[24:27]
    v_perm_b32 v248, v177, v173, s52
    v_perm_b32 v249, v185, v181, s52
    v_mfma_f32_16x16x32_bf16 v[28:31], v[252:255], v[240:243], v[28:31]
    v_perm_b32 v250, v193, v189, s52
    v_perm_b32 v251, v201, v197, s52
    v_mfma_f32_16x16x32_bf16 v[32:35], v[252:255], v[244:247], v[32:35]
    buffer_load_dwordx4 v[144:147], v5, s[48:51], s82 offen
    s_add_u32 s82, s82, s83
    v_mfma_f32_16x16x32_bf16 v[36:39], v[248:251], v[236:239], v[36:39]
    v_perm_b32 v252, v177, v173, s53
    v_perm_b32 v253, v185, v181, s53
    v_mfma_f32_16x16x32_bf16 v[40:43], v[248:251], v[240:243], v[40:43]
    v_perm_b32 v254, v193, v189, s53
    v_perm_b32 v255, v201, v197, s53
    v_mfma_f32_16x16x32_bf16 v[44:47], v[248:251], v[244:247], v[44:47]
    buffer_load_dwordx4 v[148:151], v5, s[48:51], s82 offen
    s_add_u32 s82, s82, s83
    v_mfma_f32_16x16x32_bf16 v[48:51], v[252:255], v[236:239], v[48:51]
    v_perm_b32 v248, v178, v174, s52
    v_perm_b32 v249, v186, v182, s52
    v_mfma_f32_16x16x32_bf16 v[52:55], v[252:255], v[240:243], v[52:55]
    v_perm_b32 v250, v194, v190, s52
    v_perm_b32 v251, v202, v198, s52
    v_mfma_f32_16x16x32_bf16 v[56:59], v[252:255], v[244:247], v[56:59]
    buffer_load_dwordx4 v[152:155], v5, s[48:51], s82 offen
    s_add_u32 s82, s82, s84
    v_mfma_f32_16x16x32_bf16 v[60:63], v[248:251], v[236:239], v[60:63]
    v_perm_b32 v252, v178, v174, s53
    v_perm_b32 v253, v186, v182, s53
    v_mfma_f32_16x16x32_bf16 v[64:67], v[248:251], v[240:243], v[64:67]
    v_perm_b32 v254, v194, v190, s53
    v_perm_b32 v255, v202, v198, s53
    v_mfma_f32_16x16x32_bf16 v[68:71], v[248:251], v[244:247], v[68:71]
    buffer_load_dwordx4 v[156:159], v5, s[48:51], s82 offen
    s_add_u32 s82, s82, s83
    v_mfma_f32_16x16x32_bf16 v[72:75], v[252:255], v[236:239], v[72:75]
    v_perm_b32 v248, v179, v175, s52
    v_perm_b32 v249, v187, v183, s52
    v_mfma_f32_16x16x32_bf16 v[76:79], v[252:255], v[240:243], v[76:79]
    v_perm_b32 v250, v195, v191, s52
    v_perm_b32 v251, v203, v199, s52
    v_mfma_f32_16x16x32_bf16 v[80:83], v[252:255], v[244:247], v[80:83]
    buffer_load_dwordx4 v[160:163], v5, s[48:51], s82 offen
    s_add_u32 s82, s82, s83
    v_mfma_f32_16x16x32_bf16 v[84:87], v[248:251], v[236:239], v[84:87]
    v_perm_b32 v252, v179, v175, s53
    v_perm_b32 v253, v187, v183, s53
    v_mfma_f32_16x16x32_bf16 v[88:91], v[248:251], v[240:243], v[88:91]
    v_perm_b32 v254, v195, v191, s53
    v_perm_b32 v255, v203, v199, s53
    v_mfma_f32_16x16x32_bf16 v[92:95], v[248:251], v[244:247], v[92:95]
    buffer_load_dwordx4 v[164:167], v5, s[48:51], s82 offen
    s_add_u32 s82, s82, s83
    v_mfma_f32_16x16x32_bf16 v[96:99], v[252:255], v[236:239], v[96:99]
    v_mfma_f32_16x16x32_bf16 v[100:103], v[252:255], v[240:243], v[100:103]
    v_mfma_f32_16x16x32_bf16 v[104:107], v[252:255], v[244:247], v[104:107]
    buffer_load_dwordx4 v[168:171], v5, s[48:51], s82 offen
    s_add_u32 s82, s82, s85
    ds_read_b128 v[236:239], v11 offset:0
    ds_read_b128 v[240:243], v11 offset:4096
    ds_read_b128 v[244:247], v11 offset:8192
    v_add_u32 v11, s86, v11
    s_waitcnt vmcnt(16)
    v_perm_b32 v248, v208, v204, s52
    v_perm_b32 v249, v216, v212, s52
    v_perm_b32 v250, v224, v220, s52
    v_perm_b32 v251, v232, v228, s52
    s_waitcnt lgkmcnt(0)
    s_nop 0
    v_mfma_f32_16x16x32_bf16 v[12:15], v[248:251], v[236:239], v[12:15]
    v_perm_b32 v252, v208, v204, s53
    v_perm_b32 v253, v216, v212, s53
    v_mfma_f32_16x16x32_bf16 v[16:19], v[248:251], v[240:243], v[16:19]
    v_perm_b32 v254, v224, v220, s53
    v_perm_b32 v255, v232, v228, s53
    v_mfma_f32_16x16x32_bf16 v[20:23], v[248:251], v[244:247], v[20:23]
    buffer_load_dwordx4 v[172:175], v5, s[48:51], s82 offen
    s_add_u32 s82, s82, s83
    v_mfma_f32_16x16x32_bf16 v[24:27], v[252:255], v[236:239], v[24:27]
    v_perm_b32 v248, v209, v205, s52
    v_perm_b32 v249, v217, v213, s52
    v_mfma_f32_16x16x32_bf16 v[28:31], v[252:255], v[240:243], v[28:31]
    v_perm_b32 v250, v225, v221, s52
    v_perm_b32 v251, v233, v229, s52
    v_mfma_f32_16x16x32_bf16 v[32:35], v[252:255], v[244:247], v[32:35]
    buffer_load_dwordx4 v[176:179], v5, s[48:51], s82 offen
    s_add_u32 s82, s82, s83
    v_mfma_f32_16x16x32_bf16 v[36:39], v[248:251], v[236:239], v[36:39]
    v_perm_b32 v252, v209, v205, s53
    v_perm_b32 v253, v217, v213, s53
    v_mfma_f32_16x16x32_bf16 v[40:43], v[248:251], v[240:243], v[40:43]
    v_perm_b32 v254, v225, v221, s53
    v_perm_b32 v255, v233, v229, s53
    v_mfma_f32_16x16x32_bf16 v[44:47], v[248:251], v[244:247], v[44:47]
    buffer_load_dwordx4 v[180:183], v5, s[48:51], s82 offen
    s_add_u32 s82, s82, s83
    v_mfma_f32_16x16x32_bf16 v[48:51], v[252:255], v[236:239], v[48:51]
    v_perm_b32 v248, v210, v206, s52
    v_perm_b32 v249, v218, v214, s52
    v_mfma_f32_16x16x32_bf16 v[52:55], v[252:255], v[240:243], v[52:55]
    v_perm_b32 v250, v226, v222, s52
    v_perm_b32 v251, v234, v230, s52
    v_mfma_f32_16x16x32_bf16 v[56:59], v[252:255], v[244:247], v[56:59]
    buffer_load_dwordx4 v[184:187], v5, s[48:51], s82 offen
    s_add_u32 s82, s82, s84
    v_mfma_f32_16x16x32_bf16 v[60:63], v[248:251], v[236:239], v[60:63]
    v_perm_b32 v252, v210, v206, s53
    v_perm_b32 v253, v218, v214, s53
    v_mfma_f32_16x16x32_bf16 v[64:67], v[248:251], v[240:243], v[64:67]
    v_perm_b32 v254, v226, v222, s53
    v_perm_b32 v255, v234, v230, s53
    v_mfma_f32_16x16x32_bf16 v[68:71], v[248:251], v[244:247], v[68:71]
    buffer_load_dwordx4 v[188:191], v5, s[48:51], s82 offen
    s_add_u32 s82, s82, s83
    v_mfma_f32_16x16x32_bf16 v[72:75], v[252:255], v[236:239], v[72:75]
    v_perm_b32 v248, v211, v207, s52
    v_perm_b32 v249, v219, v215, s52
    v_mfma_f32_16x16x32_bf16 v[76:79], v[252:255], v[240:243], v[76:79]
    v_perm_b32 v250, v227, v223, s52
    v_perm_b32 v251, v235, v231, s52
    v_mfma_f32_16x16x32_bf16 v[80:83], v[252:255], v[244:247], v[80:83]
    buffer_load_dwordx4 v[192:195], v5, s[48:51], s82 offen
    s_add_u32 s82, s82, s83
    v_mfma_f32_16x16x32_bf16 v[84:87], v[248:251], v[236:239], v[84:87]
    v_perm_b32 v252, v211, v207, s53
    v_perm_b32 v253, v219, v215, s53
    v_mfma_f32_16x16x32_bf16 v[88:91], v[248:251], v[240:243], v[88:91]
    v_perm_b32 v254, v227, v223, s53
    v_perm_b32 v255, v235, v231, s53
    v_mfma_f32_16x16x32_bf16 v[92:95], v[248:251], v[244:247], v[92:95]
    buffer_load_dwordx4 v[196:199], v5, s[48:51], s82 offen
    s_add_u32 s82, s82, s83
    v_mfma_f32_16x16x32_bf16 v[96:99], v[252:255], v[236:239], v[96:99]
    v_mfma_f32_16x16x32_bf16 v[100:103], v[252:255], v[240:243], v[100:103]
    v_mfma_f32_16x16x32_bf16 v[104:107], v[252:255], v[244:247], v[104:107]
    buffer_load_dwordx4 v[200:203], v5, s[48:51], s82 offen
    s_add_u32 s82, s82, s85
    v_mov_b32 v0, s88
G_w4:
    ds_read_b32 v3, v0
    s_waitcnt lgkmcnt(0)
    v_readfirstlane_b32 s31, v3
    s_cmp_ge_u32 s31, s89
    s_cbranch_scc1 G_w4_e
    s_sleep 2
    s_branch G_w4
G_w4_e:
    s_waitcnt lgkmcnt(0)
    s_mov_b64 exec, 1
    ds_add_u32 v2, v4 offset:20
    s_mov_b64 exec, -1
    ds_read_b128 v[236:239], v8 offset:0
    ds_read_b128 v[240:243], v8 offset:4096
    ds_read_b128 v[244:247], v8 offset:8192
    s_waitcnt vmcnt(16)
    v_perm_b32 v248, v112, v108, s52
    v_perm_b32 v249, v120, v116, s52
    v_perm_b32 v250, v128, v124, s52
    v_perm_b32 v251, v136, v132, s52
    s_waitcnt lgkmcnt(0)
    s_nop 0
    v_mfma_f32_16x16x32_bf16 v[12:15], v[248:251], v[236:239], v[12:15]
    v_perm_b32 v252, v112, v108, s53
    v_perm_b32 v253, v120, v116, s53
    v_mfma_f32_16x16x32_bf16 v[16:19], v[248:251], v[240:243], v[16:19]
    v_perm_b32 v254, v128, v124, s53
    v_perm_b32 v255, v136, v132, s53
    v_mfma_f32_16x16x32_bf16 v[20:23], v[248:251], v[244:247], v[20:23]
    buffer_load_dwordx4 v[204:207], v5, s[48:51], s82 offen
    s_add_u32 s82, s82, s83
    v_mfma_f32_16x16x32_bf16 v[24:27], v[252:255], v[236:239], v[24:27]
    v_perm_b32 v248, v113, v109, s52
    v_perm_b32 v249, v121, v117, s52
    v_mfma_f32_16x16x32_bf16 v[28:31], v[252:255], v[240:243], v[28:31]
    v_perm_b32 v250, v129, v125, s52
    v_perm_b32 v251, v137, v133, s52
    v_mfma_f32_16x16x32_bf16 v[32:35], v[252:255], v[244:247], v[32:35]
    buffer_load_dwordx4 v[208:211], v5, s[48:51], s82 offen
    s_add_u32 s82, s82, s83
    v_mfma_f32_16x16x32_bf16 v[36:39], v[248:251], v[236:239], v[36:39]
    v_perm_b32 v252, v113, v109, s53
    v_perm_b32 v253, v121, v117, s53
    v_mfma_f32_16x16x32_bf16 v[40:43], v[248:251], v[240:243], v[40:43]
    v_perm_b32 v254, v129, v125, s53
    v_perm_b32 v255, v137, v133, s53
    v_mfma_f32_16x16x32_bf16 v[44:47], v[248:251], v[244:247], v[44:47]
    buffer_load_dwordx4 v[212:215], v5, s[48:51], s82 offen
    s_add_u32 s82, s82, s83
    v_mfma_f32_16x16x32_bf16 v[48:51], v[252:255], v[236:239], v[48:51]
    v_perm_b32 v248, v114, v110, s52
    v_perm_b32 v249, v122, v118, s52
    v_mfma_f32_16x16x32_bf16 v[52:55], v[252:255], v[240:243], v[52:55]
    v_perm_b32 v250, v130, v126, s52
    v_perm_b32 v251, v138, v134, s52
    v_mfma_f32_16x16x32_bf16 v[56:59], v[252:255], v[244:247], v[56:59]
    buffer_load_dwordx4 v[216:219], v5, s[48:51], s82 offen
    s_add_u32 s82, s82, s84
    v_mfma_f32_16x16x32_bf16 v[60:63], v[248:251], v[236:239], v[60:63]
    v_perm_b32 v252, v114, v110, s53
    v_perm_b32 v253, v122, v118, s53
    v_mfma_f32_16x16x32_bf16 v[64:67], v[248:251], v[240:243], v[64:67]
    v_perm_b32 v254, v130, v126, s53
    v_perm_b32 v255, v138, v134, s53
    v_mfma_f32_16x16x32_bf16 v[68:71], v[248:251], v[244:247], v[68:71]
    buffer_load_dwordx4 v[220:223], v5, s[48:51], s82 offen
    s_add_u32 s82, s82, s83
    v_mfma_f32_16x16x32_bf16 v[72:75], v[252:255], v[236:239], v[72:75]
    v_perm_b32 v248, v115, v111, s52
    v_perm_b32 v249, v123, v119, s52
    v_mfma_f32_16x16x32_bf16 v[76:79], v[252:255], v[240:243], v[76:79]
    v_perm_b32 v250, v131, v127, s52
    v_perm_b32 v251, v139, v135, s52
    v_mfma_f32_16x16x32_bf16 v[80:83], v[252:255], v[244:247], v[80:83]
    buffer_load_dwordx4 v[224:227], v5, s[48:51], s82 offen
    s_add_u32 s82, s82, s83
    v_mfma_f32_16x16x32_bf16 v[84:87], v[248:251], v[236:239], v[84:87]
    v_perm_b32 v252, v115, v111, s53
    v_perm_b32 v253, v123, v119, s53
    v_mfma_f32_16x16x32_bf16 v[88:91], v[248:251], v[240:243], v[88:91]
    v_perm_b32 v254, v131, v127, s53
    v_perm_b32 v255, v139, v135, s53
    v_mfma_f32_16x16x32_bf16 v[92:95], v[248:251], v[244:247], v[92:95]
    buffer_load_dwordx4 v[228:231], v5, s[48:51], s82 offen
    s_add_u32 s82, s82, s83
    v_mfma_f32_16x16x32_bf16 v[96:99], v[252:255], v[236:239], v[96:99]
    v_mfma_f32_16x16x32_bf16 v[100:103], v[252:255], v[240:243], v[100:103]
    v_mfma_f32_16x16x32_bf16 v[104:107], v[252:255], v[244:247], v[104:107]
    buffer_load_dwordx4 v[232:235], v5, s[48:51], s82 offen
    s_add_u32 s82, s82, s85
    ds_read_b128 v[236:239], v9 offset:0
    ds_read_b128 v[240:243], v9 offset:4096
    ds_read_b128 v[244:247], v9 offset:8192
    s_waitcnt vmcnt(16)
    v_perm_b32 v248, v144, v140, s52
    v_perm_b32 v249, v152, v148, s52
    v_perm_b32 v250, v160, v156, s52
    v_perm_b32 v251, v168, v164, s52
    s_waitcnt lgkmcnt(0)
    s_nop 0
    v_mfma_f32_16x16x32_bf16 v[12:15], v[248:251], v[236:239], v[12:15]
    v_perm_b32 v252, v144, v140, s53
    v_perm_b32 v253, v152, v148, s53
    v_mfma_f32_16x16x32_bf16 v[16:19], v[248:251], v[240:243], v[16:19]
    v_perm_b32 v254, v160, v156, s53
    v_perm_b32 v255, v168, v164, s53
    v_mfma_f32_16x16x32_bf16 v[20:23], v[248:251], v[244:247], v[20:23]
    s_nop 0
    v_mfma_f32_16x16x32_bf16 v[24:27], v[252:255], v[236:239], v[24:27]
    v_perm_b32 v248, v145, v141, s52
    v_perm_b32 v249, v153, v149, s52
    v_mfma_f32_16x16x32_bf16 v[28:31], v[252:255], v[240:243], v[28:31]
    v_perm_b32 v250, v161, v157, s52
    v_perm_b32 v251, v169, v165, s52
    v_mfma_f32_16x16x32_bf16 v[32:35], v[252:255], v[244:247], v[32:35]
    s_nop 0
    v_mfma_f32_16x16x32_bf16 v[36:39], v[248:251], v[236:239], v[36:39]
    v_perm_b32 v252, v145, v141, s53
    v_perm_b32 v253, v153, v149, s53
    v_mfma_f32_16x16x32_bf16 v[40:43], v[248:251], v[240:243], v[40:43]
    v_perm_b32 v254, v161, v157, s53
    v_perm_b32 v255, v169, v165, s53
    v_mfma_f32_16x16x32_bf16 v[44:47], v[248:251], v[244:247], v[44:47]
    s_nop 0
    v_mfma_f32_16x16x32_bf16 v[48:51], v[252:255], v[236:239], v[48:51]
    v_perm_b32 v248, v146, v142, s52
    v_perm_b32 v249, v154, v150, s52
    v_mfma_f32_16x16x32_bf16 v[52:55], v[252:255], v[240:243], v[52:55]
    v_perm_b32 v250, v162, v158, s52
    v_perm_b32 v251, v170, v166, s52
    v_mfma_f32_16x16x32_bf16 v[56:59], v[252:255], v[244:247], v[56:59]
    s_nop 0
    v_mfma_f32_16x16x32_bf16 v[60:63], v[248:251], v[236:239], v[60:63]
    v_perm_b32 v252, v146, v142, s53
    v_perm_b32 v253, v154, v150, s53
    v_mfma_f32_16x16x32_bf16 v[64:67], v[248:251], v[240:243], v[64:67]
    v_perm_b32 v254, v162, v158, s53
    v_perm_b32 v255, v170, v166, s53
    v_mfma_f32_16x16x32_bf16 v[68:71], v[248:251], v[244:247], v[68:71]
    s_nop 0
    v_mfma_f32_16x16x32_bf16 v[72:75], v[252:255], v[236:239], v[72:75]
    v_perm_b32 v248, v147, v143, s52
    v_perm_b32 v249, v155, v151, s52
    v_mfma_f32_16x16x32_bf16 v[76:79], v[252:255], v[240:243], v[76:79]
    v_perm_b32 v250, v163, v159, s52
    v_perm_b32 v251, v171, v167, s52
    v_mfma_f32_16x16x32_bf16 v[80:83], v[252:255], v[244:247], v[80:83]
    s_nop 0
    v_mfma_f32_16x16x32_bf16 v[84:87], v[248:251], v[236:239], v[84:87]
    v_perm_b32 v252, v147, v143, s53
    v_perm_b32 v253, v155, v151, s53
    v_mfma_f32_16x16x32_bf16 v[88:91], v[248:251], v[240:243], v[88:91]
    v_perm_b32 v254, v163, v159, s53
    v_perm_b32 v255, v171, v167, s53
    v_mfma_f32_16x16x32_bf16 v[92:95], v[248:251], v[244:247], v[92:95]
    s_nop 0
    v_mfma_f32_16x16x32_bf16 v[96:99], v[252:255], v[236:239], v[96:99]
    v_mfma_f32_16x16x32_bf16 v[100:103], v[252:255], v[240:243], v[100:103]
    v_mfma_f32_16x16x32_bf16 v[104:107], v[252:255], v[244:247], v[104:107]
    ds_read_b128 v[236:239], v10 offset:0
    ds_read_b128 v[240:243], v10 offset:4096
    ds_read_b128 v[244:247], v10 offset:8192
    s_waitcnt vmcnt(8)
    v_perm_b32 v248, v176, v172, s52
    v_perm_b32 v249, v184, v180, s52
    v_perm_b32 v250, v192, v188, s52
    v_perm_b32 v251, v200, v196, s52
    s_waitcnt lgkmcnt(0)
    s_nop 0
    v_mfma_f32_16x16x32_bf16 v[12:15], v[248:251], v[236:239], v[12:15]
    v_perm_b32 v252, v176, v172, s53
    v_perm_b32 v253, v184, v180, s53
    v_mfma_f32_16x16x32_bf16 v[16:19], v[248:251], v[240:243], v[16:19]
    v_perm_b32 v254, v192, v188, s53
    v_perm_b32 v255, v200, v196, s53
    v_mfma_f32_16x16x32_bf16 v[20:23], v[248:251], v[244:247], v[20:23]
    s_nop 0
    v_mfma_f32_16x16x32_bf16 v[24:27], v[252:255], v[236:239], v[24:27]
    v_perm_b32 v248, v177, v173, s52
    v_perm_b32 v249, v185, v181, s52
    v_mfma_f32_16x16x32_bf16 v[28:31], v[252:255], v[240:243], v[28:31]
    v_perm_b32 v250, v193, v189, s52
    v_perm_b32 v251, v201, v197, s52
    v_mfma_f32_16x16x32_bf16 v[32:35], v[252:255], v[244:247], v[32:35]
    s_nop 0
    v_mfma_f32_16x16x32_bf16 v[36:39], v[248:251], v[236:239], v[36:39]
    v_perm_b32 v252, v177, v173, s53
    v_perm_b32 v253, v185, v181, s53
    v_mfma_f32_16x16x32_bf16 v[40:43], v[248:251], v[240:243], v[40:43]
    v_perm_b32 v254, v193, v189, s53
    v_perm_b32 v255, v201, v197, s53
    v_mfma_f32_16x16x32_bf16 v[44:47], v[248:251], v[244:247], v[44:47]
    s_nop 0
    v_mfma_f32_16x16x32_bf16 v[48:51], v[252:255], v[236:239], v[48:51]
    v_perm_b32 v248, v178, v174, s52
    v_perm_b32 v249, v186, v182, s52
    v_mfma_f32_16x16x32_bf16 v[52:55], v[252:255], v[240:243], v[52:55]
    v_perm_b32 v250, v194, v190, s52
    v_perm_b32 v251, v202, v198, s52
    v_mfma_f32_16x16x32_bf16 v[56:59], v[252:255], v[244:247], v[56:59]
    s_nop 0
    v_mfma_f32_16x16x32_bf16 v[60:63], v[248:251], v[236:239], v[60:63]
    v_perm_b32 v252, v178, v174, s53
    v_perm_b32 v253, v186, v182, s53
    v_mfma_f32_16x16x32_bf16 v[64:67], v[248:251], v[240:243], v[64:67]
    v_perm_b32 v254, v194, v190, s53
    v_perm_b32 v255, v202, v198, s53
    v_mfma_f32_16x16x32_bf16 v[68:71], v[248:251], v[244:247], v[68:71]
    s_nop 0
    v_mfma_f32_16x16x32_bf16 v[72:75], v[252:255], v[236:239], v[72:75]
    v_perm_b32 v248, v179, v175, s52
    v_perm_b32 v249, v187, v183, s52
    v_mfma_f32_16x16x32_bf16 v[76:79], v[252:255], v[240:243], v[76:79]
    v_perm_b32 v250, v195, v191, s52
    v_perm_b32 v251, v203, v199, s52
    v_mfma_f32_16x16x32_bf16 v[80:83], v[252:255], v[244:247], v[80:83]
    s_nop 0
    v_mfma_f32_16x16x32_bf16 v[84:87], v[248:251], v[236:239], v[84:87]
    v_perm_b32 v252, v179, v175, s53
    v_perm_b32 v253, v187, v183, s53
    v_mfma_f32_16x16x32_bf16 v[88:91], v[248:251], v[240:243], v[88:91]
    v_perm_b32 v254, v195, v191, s53
    v_perm_b32 v255, v203, v199, s53
    v_mfma_f32_16x16x32_bf16 v[92:95], v[248:251], v[244:247], v[92:95]
    s_nop 0
    v_mfma_f32_16x16x32_bf16 v[96:99], v[252:255], v[236:239], v[96:99]
    v_mfma_f32_16x16x32_bf16 v[100:103], v[252:255], v[240:243], v[100:103]
    v_mfma_f32_16x16x32_bf16 v[104:107], v[252:255], v[244:247], v[104:107]
    ds_read_b128 v[236:239], v11 offset:0
    ds_read_b128 v[240:243], v11 offset:4096
    ds_read_b128 v[244:247], v11 offset:8192
    s_waitcnt vmcnt(0)
    v_perm_b32 v248, v208, v204, s52
    v_perm_b32 v249, v216, v212, s52
    v_perm_b32 v250, v224, v220, s52
    v_perm_b32 v251, v232, v228, s52
    s_waitcnt lgkmcnt(0)
    s_nop 0
    v_mfma_f32_16x16x32_bf16 v[12:15], v[248:251], v[236:239], v[12:15]
    v_perm_b32 v252, v208, v204, s53
    v_perm_b32 v253, v216, v212, s53
    v_mfma_f32_16x16x32_bf16 v[16:19], v[248:251], v[240:243], v[16:19]
    v_perm_b32 v254, v224, v220, s53
    v_perm_b32 v255, v232, v228, s53
    v_mfma_f32_16x16x32_bf16 v[20:23], v[248:251], v[244:247], v[20:23]
    s_nop 0
    v_mfma_f32_16x16x32_bf16 v[24:27], v[252:255], v[236:239], v[24:27]
    v_perm_b32 v248, v209, v205, s52
    v_perm_b32 v249, v217, v213, s52
    v_mfma_f32_16x16x32_bf16 v[28:31], v[252:255], v[240:243], v[28:31]
    v_perm_b32 v250, v225, v221, s52
    v_perm_b32 v251, v233, v229, s52
    v_mfma_f32_16x16x32_bf16 v[32:35], v[252:255], v[244:247], v[32:35]
    s_nop 0
    v_mfma_f32_16x16x32_bf16 v[36:39], v[248:251], v[236:239], v[36:39]
    v_perm_b32 v252, v209, v205, s53
    v_perm_b32 v253, v217, v213, s53
    v_mfma_f32_16x16x32_bf16 v[40:43], v[248:251], v[240:243], v[40:43]
    v_perm_b32 v254, v225, v221, s53
    v_perm_b32 v255, v233, v229, s53
    v_mfma_f32_16x16x32_bf16 v[44:47], v[248:251], v[244:247], v[44:47]
    s_nop 0
    v_mfma_f32_16x16x32_bf16 v[48:51], v[252:255], v[236:239], v[48:51]
    v_perm_b32 v248, v210, v206, s52
    v_perm_b32 v249, v218, v214, s52
    v_mfma_f32_16x16x32_bf16 v[52:55], v[252:255], v[240:243], v[52:55]
    v_perm_b32 v250, v226, v222, s52
    v_perm_b32 v251, v234, v230, s52
    v_mfma_f32_16x16x32_bf16 v[56:59], v[252:255], v[244:247], v[56:59]
    s_nop 0
    v_mfma_f32_16x16x32_bf16 v[60:63], v[248:251], v[236:239], v[60:63]
    v_perm_b32 v252, v210, v206, s53
    v_perm_b32 v253, v218, v214, s53
    v_mfma_f32_16x16x32_bf16 v[64:67], v[248:251], v[240:243], v[64:67]
    v_perm_b32 v254, v226, v222, s53
    v_perm_b32 v255, v234, v230, s53
    v_mfma_f32_16x16x32_bf16 v[68:71], v[248:251], v[244:247], v[68:71]
    s_nop 0
    v_mfma_f32_16x16x32_bf16 v[72:75], v[252:255], v[236:239], v[72:75]
    v_perm_b32 v248, v211, v207, s52
    v_perm_b32 v249, v219, v215, s52
    v_mfma_f32_16x16x32_bf16 v[76:79], v[252:255], v[240:243], v[76:79]
    v_perm_b32 v250, v227, v223, s52
    v_perm_b32 v251, v235, v231, s52
    v_mfma_f32_16x16x32_bf16 v[80:83], v[252:255], v[244:247], v[80:83]
    s_nop 0
    v_mfma_f32_16x16x32_bf16 v[84:87], v[248:251], v[236:239], v[84:87]
    v_perm_b32 v252, v211, v207, s53
    v_perm_b32 v253, v219, v215, s53
    v_mfma_f32_16x16x32_bf16 v[88:91], v[248:251], v[240:243], v[88:91]
    v_perm_b32 v254, v227, v223, s53
    v_perm_b32 v255, v235, v231, s53
    v_mfma_f32_16x16x32_bf16 v[92:95], v[248:251], v[244:247], v[92:95]
    s_nop 0
    v_mfma_f32_16x16x32_bf16 v[96:99], v[252:255], v[236:239], v[96:99]
    v_mfma_f32_16x16x32_bf16 v[100:103], v[252:255], v[240:243], v[100:103]
    v_mfma_f32_16x16x32_bf16 v[104:107], v[252:255], v[244:247], v[104:107]
    s_nop 7
    s_setpc_b64 s[38:39]
S_red:
    s_cmp_eq_u32 s37, 3
    s_cbranch_scc1 S_red_e
    s_mov_b32 s60, s18
    s_mov_b32 s61, s19
    s_mov_b32 s62, 256
    s_mov_b32 s63, 0x20000
    s_lshl_b32 s30, s26, 2
S_r0:
    buffer_load_dword v3, v2, s[60:63], s30 offen sc0 sc1
    s_waitcnt vmcnt(0)
    v_readfirstlane_b32 s31, v3
    s_cmp_ge_u32 s31, 16
    s_cbranch_scc0 S_r0
    s_add_u32 s60, s20, 0x1800000
    s_addc_u32 s61, s21, 0
    s_mov_b32 s62, 4096
    s_lshl_b32 s64, s59, 4
    s_add_u32 s64, s64, s26
    s_lshl_b32 s30, s64, 7
    v_lshrrev_b32 v9, 2, v1
    v_and_b32 v9, 60, v9
    s_lshr_b32 s65, s29, 1
    s_mul_i32 s65, s65, 3
    s_add_u32 s65, s65, s37
    s_mul_i32 s66, s64, 786432
    s_lshl_b32 s31, s65, 10
    s_add_u32 s66, s66, s31
    s_add_u32 s68, s20, s66
    s_addc_u32 s69, s21, 0
    s_mov_b32 s70, 738304
    s_mov_b32 s71, 0x20000
    s_mul_hi_u32 s66, s65, 0x15555556
    s_mul_i32 s31, s66, 12
    s_sub_u32 s65, s65, s31
    s_mul_i32 s64, s26, 48
    s_lshr_b32 s31, s65, 2
    s_lshl_b32 s31, s31, 4
    s_add_u32 s64, s64, s31
    s_lshl_b32 s64, s64, 11
    s_lshl_b32 s31, s59, 10
    s_add_u32 s64, s64, s31
    s_lshl_b32 s31, s66, 8
    s_add_u32 s64, s64, s31
    s_and_b32 s31, s65, 3
    s_lshl_b32 s31, s31, 4
    s_add_u32 s64, s64, s31
    v_lshlrev_b32 v11, 9, v9
    v_lshrrev_b32 v8, 8, v1
    v_lshl_add_u32 v11, v8, 6, v11
S_r1:
    buffer_load_dword v3, v9, s[60:63], s30 offen sc0 sc1
    s_waitcnt vmcnt(0)
    v_cmp_ne_u32 vcc, 1, v3
    s_cbranch_vccz S_r2
    s_sleep 4
    s_branch S_r1
S_r2:
    s_mov_b32 s31, 0
    buffer_load_dwordx4 v[12:15], v1, s[68:71], s31 offen sc0 sc1
    s_mov_b32 s31, 49152
    buffer_load_dwordx4 v[16:19], v1, s[68:71], s31 offen sc0 sc1
    s_mov_b32 s31, 98304
    buffer_load_dwordx4 v[20:23], v1, s[68:71], s31 offen sc0 sc1
    s_mov_b32 s31, 147456
    buffer_load_dwordx4 v[24:27], v1, s[68:71], s31 offen sc0 sc1
    s_mov_b32 s31, 196608
    buffer_load_dwordx4 v[28:31], v1, s[68:71], s31 offen sc0 sc1
    s_mov_b32 s31, 245760
    buffer_load_dwordx4 v[32:35], v1, s[68:71], s31 offen sc0 sc1
    s_mov_b32 s31, 294912
    buffer_load_dwordx4 v[36:39], v1, s[68:71], s31 offen sc0 sc1
    s_mov_b32 s31, 344064
    buffer_load_dwordx4 v[40:43], v1, s[68:71], s31 offen sc0 sc1
    s_mov_b32 s31, 393216
    buffer_load_dwordx4 v[44:47], v1, s[68:71], s31 offen sc0 sc1
    s_mov_b32 s31, 442368
    buffer_load_dwordx4 v[48:51], v1, s[68:71], s31 offen sc0 sc1
    s_mov_b32 s31, 491520
    buffer_load_dwordx4 v[52:55], v1, s[68:71], s31 offen sc0 sc1
    s_mov_b32 s31, 540672
    buffer_load_dwordx4 v[56:59], v1, s[68:71], s31 offen sc0 sc1
    s_mov_b32 s31, 589824
    buffer_load_dwordx4 v[60:63], v1, s[68:71], s31 offen sc0 sc1
    s_mov_b32 s31, 638976
    buffer_load_dwordx4 v[64:67], v1, s[68:71], s31 offen sc0 sc1
    s_mov_b32 s31, 688128
    buffer_load_dwordx4 v[68:71], v1, s[68:71], s31 offen sc0 sc1
    s_mov_b32 s31, 737280
    buffer_load_dwordx4 v[72:75], v1, s[68:71], s31 offen sc0 sc1
    s_mov_b32 s60, s16
    s_mov_b32 s61, s17
    s_mov_b32 s62, 1572864
    s_waitcnt vmcnt(15)
    v_lshlrev_b32 v80, 16, v12
    v_and_b32 v81, 0xffff0000, v12
    v_lshlrev_b32 v82, 16, v13
    v_and_b32 v83, 0xffff0000, v13
    v_lshlrev_b32 v84, 16, v14
    v_and_b32 v85, 0xffff0000, v14
    v_lshlrev_b32 v86, 16, v15
    v_and_b32 v87, 0xffff0000, v15
    s_waitcnt vmcnt(14)
    v_lshlrev_b32 v88, 16, v16
    v_and_b32 v89, 0xffff0000, v16
    v_add_f32 v80, v80, v88
    v_add_f32 v81, v81, v89
    v_lshlrev_b32 v88, 16, v17
    v_and_b32 v89, 0xffff0000, v17
    v_add_f32 v82, v82, v88
    v_add_f32 v83, v83, v89
    v_lshlrev_b32 v88, 16, v18
    v_and_b32 v89, 0xffff0000, v18
    v_add_f32 v84, v84, v88
    v_add_f32 v85, v85, v89
    v_lshlrev_b32 v88, 16, v19
    v_and_b32 v89, 0xffff0000, v19
    v_add_f32 v86, v86, v88
    v_add_f32 v87, v87, v89
    s_waitcnt vmcnt(13)
    v_lshlrev_b32 v88, 16, v20
    v_and_b32 v89, 0xffff0000, v20
    v_add_f32 v80, v80, v88
    v_add_f32 v81, v81, v89
    v_lshlrev_b32 v88, 16, v21
    v_and_b32 v89, 0xffff0000, v21
    v_add_f32 v82, v82, v88
    v_add_f32 v83, v83, v89
    v_lshlrev_b32 v88, 16, v22
    v_and_b32 v89, 0xffff0000, v22
    v_add_f32 v84, v84, v88
    v_add_f32 v85, v85, v89
    v_lshlrev_b32 v88, 16, v23
    v_and_b32 v89, 0xffff0000, v23
    v_add_f32 v86, v86, v88
    v_add_f32 v87, v87, v89
    s_waitcnt vmcnt(12)
    v_lshlrev_b32 v88, 16, v24
    v_and_b32 v89, 0xffff0000, v24
    v_add_f32 v80, v80, v88
    v_add_f32 v81, v81, v89
    v_lshlrev_b32 v88, 16, v25
    v_and_b32 v89, 0xffff0000, v25
    v_add_f32 v82, v82, v88
    v_add_f32 v83, v83, v89
    v_lshlrev_b32 v88, 16, v26
    v_and_b32 v89, 0xffff0000, v26
    v_add_f32 v84, v84, v88
    v_add_f32 v85, v85, v89
    v_lshlrev_b32 v88, 16, v27
    v_and_b32 v89, 0xffff0000, v27
    v_add_f32 v86, v86, v88
    v_add_f32 v87, v87, v89
    s_waitcnt vmcnt(11)
    v_lshlrev_b32 v88, 16, v28
    v_and_b32 v89, 0xffff0000, v28
    v_add_f32 v80, v80, v88
    v_add_f32 v81, v81, v89
    v_lshlrev_b32 v88, 16, v29
    v_and_b32 v89, 0xffff0000, v29
    v_add_f32 v82, v82, v88
    v_add_f32 v83, v83, v89
    v_lshlrev_b32 v88, 16, v30
    v_and_b32 v89, 0xffff0000, v30
    v_add_f32 v84, v84, v88
    v_add_f32 v85, v85, v89
    v_lshlrev_b32 v88, 16, v31
    v_and_b32 v89, 0xffff0000, v31
    v_add_f32 v86, v86, v88
    v_add_f32 v87, v87, v89
    s_waitcnt vmcnt(10)
    v_lshlrev_b32 v88, 16, v32
    v_and_b32 v89, 0xffff0000, v32
    v_add_f32 v80, v80, v88
    v_add_f32 v81, v81, v89
    v_lshlrev_b32 v88, 16, v33
    v_and_b32 v89, 0xffff0000, v33
    v_add_f32 v82, v82, v88
    v_add_f32 v83, v83, v89
    v_lshlrev_b32 v88, 16, v34
    v_and_b32 v89, 0xffff0000, v34
    v_add_f32 v84, v84, v88
    v_add_f32 v85, v85, v89
    v_lshlrev_b32 v88, 16, v35
    v_and_b32 v89, 0xffff0000, v35
    v_add_f32 v86, v86, v88
    v_add_f32 v87, v87, v89
    s_waitcnt vmcnt(9)
    v_lshlrev_b32 v88, 16, v36
    v_and_b32 v89, 0xffff0000, v36
    v_add_f32 v80, v80, v88
    v_add_f32 v81, v81, v89
    v_lshlrev_b32 v88, 16, v37
    v_and_b32 v89, 0xffff0000, v37
    v_add_f32 v82, v82, v88
    v_add_f32 v83, v83, v89
    v_lshlrev_b32 v88, 16, v38
    v_and_b32 v89, 0xffff0000, v38
    v_add_f32 v84, v84, v88
    v_add_f32 v85, v85, v89
    v_lshlrev_b32 v88, 16, v39
    v_and_b32 v89, 0xffff0000, v39
    v_add_f32 v86, v86, v88
    v_add_f32 v87, v87, v89
    s_waitcnt vmcnt(8)
    v_lshlrev_b32 v88, 16, v40
    v_and_b32 v89, 0xffff0000, v40
    v_add_f32 v80, v80, v88
    v_add_f32 v81, v81, v89
    v_lshlrev_b32 v88, 16, v41
    v_and_b32 v89, 0xffff0000, v41
    v_add_f32 v82, v82, v88
    v_add_f32 v83, v83, v89
    v_lshlrev_b32 v88, 16, v42
    v_and_b32 v89, 0xffff0000, v42
    v_add_f32 v84, v84, v88
    v_add_f32 v85, v85, v89
    v_lshlrev_b32 v88, 16, v43
    v_and_b32 v89, 0xffff0000, v43
    v_add_f32 v86, v86, v88
    v_add_f32 v87, v87, v89
    s_waitcnt vmcnt(7)
    v_lshlrev_b32 v88, 16, v44
    v_and_b32 v89, 0xffff0000, v44
    v_add_f32 v80, v80, v88
    v_add_f32 v81, v81, v89
    v_lshlrev_b32 v88, 16, v45
    v_and_b32 v89, 0xffff0000, v45
    v_add_f32 v82, v82, v88
    v_add_f32 v83, v83, v89
    v_lshlrev_b32 v88, 16, v46
    v_and_b32 v89, 0xffff0000, v46
    v_add_f32 v84, v84, v88
    v_add_f32 v85, v85, v89
    v_lshlrev_b32 v88, 16, v47
    v_and_b32 v89, 0xffff0000, v47
    v_add_f32 v86, v86, v88
    v_add_f32 v87, v87, v89
    s_waitcnt vmcnt(6)
    v_lshlrev_b32 v88, 16, v48
    v_and_b32 v89, 0xffff0000, v48
    v_add_f32 v80, v80, v88
    v_add_f32 v81, v81, v89
    v_lshlrev_b32 v88, 16, v49
    v_and_b32 v89, 0xffff0000, v49
    v_add_f32 v82, v82, v88
    v_add_f32 v83, v83, v89
    v_lshlrev_b32 v88, 16, v50
    v_and_b32 v89, 0xffff0000, v50
    v_add_f32 v84, v84, v88
    v_add_f32 v85, v85, v89
    v_lshlrev_b32 v88, 16, v51
    v_and_b32 v89, 0xffff0000, v51
    v_add_f32 v86, v86, v88
    v_add_f32 v87, v87, v89
    s_waitcnt vmcnt(5)
    v_lshlrev_b32 v88, 16, v52
    v_and_b32 v89, 0xffff0000, v52
    v_add_f32 v80, v80, v88
    v_add_f32 v81, v81, v89
    v_lshlrev_b32 v88, 16, v53
    v_and_b32 v89, 0xffff0000, v53
    v_add_f32 v82, v82, v88
    v_add_f32 v83, v83, v89
    v_lshlrev_b32 v88, 16, v54
    v_and_b32 v89, 0xffff0000, v54
    v_add_f32 v84, v84, v88
    v_add_f32 v85, v85, v89
    v_lshlrev_b32 v88, 16, v55
    v_and_b32 v89, 0xffff0000, v55
    v_add_f32 v86, v86, v88
    v_add_f32 v87, v87, v89
    s_waitcnt vmcnt(4)
    v_lshlrev_b32 v88, 16, v56
    v_and_b32 v89, 0xffff0000, v56
    v_add_f32 v80, v80, v88
    v_add_f32 v81, v81, v89
    v_lshlrev_b32 v88, 16, v57
    v_and_b32 v89, 0xffff0000, v57
    v_add_f32 v82, v82, v88
    v_add_f32 v83, v83, v89
    v_lshlrev_b32 v88, 16, v58
    v_and_b32 v89, 0xffff0000, v58
    v_add_f32 v84, v84, v88
    v_add_f32 v85, v85, v89
    v_lshlrev_b32 v88, 16, v59
    v_and_b32 v89, 0xffff0000, v59
    v_add_f32 v86, v86, v88
    v_add_f32 v87, v87, v89
    s_waitcnt vmcnt(3)
    v_lshlrev_b32 v88, 16, v60
    v_and_b32 v89, 0xffff0000, v60
    v_add_f32 v80, v80, v88
    v_add_f32 v81, v81, v89
    v_lshlrev_b32 v88, 16, v61
    v_and_b32 v89, 0xffff0000, v61
    v_add_f32 v82, v82, v88
    v_add_f32 v83, v83, v89
    v_lshlrev_b32 v88, 16, v62
    v_and_b32 v89, 0xffff0000, v62
    v_add_f32 v84, v84, v88
    v_add_f32 v85, v85, v89
    v_lshlrev_b32 v88, 16, v63
    v_and_b32 v89, 0xffff0000, v63
    v_add_f32 v86, v86, v88
    v_add_f32 v87, v87, v89
    s_waitcnt vmcnt(2)
    v_lshlrev_b32 v88, 16, v64
    v_and_b32 v89, 0xffff0000, v64
    v_add_f32 v80, v80, v88
    v_add_f32 v81, v81, v89
    v_lshlrev_b32 v88, 16, v65
    v_and_b32 v89, 0xffff0000, v65
    v_add_f32 v82, v82, v88
    v_add_f32 v83, v83, v89
    v_lshlrev_b32 v88, 16, v66
    v_and_b32 v89, 0xffff0000, v66
    v_add_f32 v84, v84, v88
    v_add_f32 v85, v85, v89
    v_lshlrev_b32 v88, 16, v67
    v_and_b32 v89, 0xffff0000, v67
    v_add_f32 v86, v86, v88
    v_add_f32 v87, v87, v89
    s_waitcnt vmcnt(1)
    v_lshlrev_b32 v88, 16, v68
    v_and_b32 v89, 0xffff0000, v68
    v_add_f32 v80, v80, v88
    v_add_f32 v81, v81, v89
    v_lshlrev_b32 v88, 16, v69
    v_and_b32 v89, 0xffff0000, v69
    v_add_f32 v82, v82, v88
    v_add_f32 v83, v83, v89
    v_lshlrev_b32 v88, 16, v70
    v_and_b32 v89, 0xffff0000, v70
    v_add_f32 v84, v84, v88
    v_add_f32 v85, v85, v89
    v_lshlrev_b32 v88, 16, v71
    v_and_b32 v89, 0xffff0000, v71
    v_add_f32 v86, v86, v88
    v_add_f32 v87, v87, v89
    s_waitcnt vmcnt(0)
    v_lshlrev_b32 v88, 16, v72
    v_and_b32 v89, 0xffff0000, v72
    v_add_f32 v80, v80, v88
    v_add_f32 v81, v81, v89
    v_lshlrev_b32 v88, 16, v73
    v_and_b32 v89, 0xffff0000, v73
    v_add_f32 v82, v82, v88
    v_add_f32 v83, v83, v89
    v_lshlrev_b32 v88, 16, v74
    v_and_b32 v89, 0xffff0000, v74
    v_add_f32 v84, v84, v88
    v_add_f32 v85, v85, v89
    v_lshlrev_b32 v88, 16, v75
    v_and_b32 v89, 0xffff0000, v75
    v_add_f32 v86, v86, v88
    v_add_f32 v87, v87, v89
    v_cvt_pk_bf16_f32 v92, v80, v81
    v_cvt_pk_bf16_f32 v93, v82, v83
    v_cvt_pk_bf16_f32 v94, v84, v85
    v_cvt_pk_bf16_f32 v95, v86, v87
    buffer_store_dwordx4 v[92:95], v11, s[60:63], s64 offen
    s_waitcnt vmcnt(0)
S_red_e:
    s_setpc_b64 s[38:39]
R_gemm:
    s_mov_b32 s90, 32
    s_mov_b32 s97, 0
    s_setprio 3
    s_mov_b32 s52, 0x05040100
    s_mov_b32 s53, 0x07060302
    s_and_b32 s32, s25, 1
    s_lshr_b32 s33, s25, 1
    s_mul_i32 s41, s25, 12288
    s_add_u32 s41, s41, 1024
    s_xor_b32 s30, s25, 2
    s_mul_i32 s42, s30, 12288
    s_add_u32 s42, s42, 1024
    v_and_b32 v24, 15, v0
    v_lshrrev_b32 v25, 4, v0
    v_lshlrev_b32 v26, 16, v25
    v_lshl_add_u32 v5, v24, 4, v26
    v_lshlrev_b32 v26, 10, v25
    v_lshlrev_b32 v27, 1, v25
    v_xor_b32 v27, v27, v24
    v_lshl_add_u32 v6, v27, 4, v26
    v_xor_b32 v27, 8, v27
    v_lshl_add_u32 v7, v27, 4, v26
    s_mul_i32 s34, s26, 49152
    s_lshl_b32 s30, s25, 8
    s_add_u32 s34, s34, s30
    s_add_u32 s35, s29, s32
    s_lshl_b32 s35, s35, 8
    s_lshl_b32 s30, s33, 21
    s_add_u32 s35, s35, s30
    s_mov_b32 s46, 48384
    s_mov_b32 s47, 0x20000
    s_mov_b32 s50, 2089216
    s_mov_b32 s51, 0x20000
    s_mov_b32 s83, 8192
    s_mov_b32 s84, 8192
    s_mov_b32 s85, 204800
    s_mov_b32 s86, 12288
    s_lshl_b32 s87, s33, 3
    s_add_u32 s87, s87, 48
    s_add_u32 s88, s87, 4
    s_mov_b32 s43, 0
    s_mov_b32 s55, 0
    s_add_u32 s44, s72, s34
    s_addc_u32 s45, s73, 0
    s_add_u32 s48, s78, s35
    s_addc_u32 s49, s79, 0
G_q:
    s_add_u32 m0, s41, 0
    s_mov_b32 s30, 0
    buffer_load_dwordx4 v6, s[44:47], s30 offen offset:0 lds
    s_mov_b32 s30, 3072
    buffer_load_dwordx4 v7, s[44:47], s30 offen offset:1024 lds
    s_mov_b32 s30, 6144
    buffer_load_dwordx4 v6, s[44:47], s30 offen offset:2048 lds
    s_mov_b32 s30, 9216
    buffer_load_dwordx4 v7, s[44:47], s30 offen offset:3072 lds
    s_add_u32 m0, s41, 4096
    s_mov_b32 s30, 16384
    buffer_load_dwordx4 v6, s[44:47], s30 offen offset:0 lds
    s_mov_b32 s30, 19456
    buffer_load_dwordx4 v7, s[44:47], s30 offen offset:1024 lds
    s_mov_b32 s30, 22528
    buffer_load_dwordx4 v6, s[44:47], s30 offen offset:2048 lds
    s_mov_b32 s30, 25600
    buffer_load_dwordx4 v7, s[44:47], s30 offen offset:3072 lds
    s_add_u32 m0, s41, 8192
    s_mov_b32 s30, 32768
    buffer_load_dwordx4 v6, s[44:47], s30 offen offset:0 lds
    s_mov_b32 s30, 35840
    buffer_load_dwordx4 v7, s[44:47], s30 offen offset:1024 lds
    s_mov_b32 s30, 38912
    buffer_load_dwordx4 v6, s[44:47], s30 offen offset:2048 lds
    s_mov_b32 s30, 41984
    buffer_load_dwordx4 v7, s[44:47], s30 offen offset:3072 lds
    s_cmp_eq_u32 s55, 1
    s_cbranch_scc1 G_q1
L_p_1:
    ds_read_b32 v3, v2 offset:16
    s_waitcnt lgkmcnt(0)
    v_readfirstlane_b32 s31, v3
    s_cmp_ge_u32 s31, 2
    s_cbranch_scc1 L_q_2
    s_branch L_p_1
L_q_2:
    s_call_b64 s[38:39], S_w
    s_waitcnt vmcnt(32)
    s_branch G_q2
G_q1:
    s_waitcnt vmcnt(0)
G_q2:
    s_add_u32 s89, s55, 1
    s_lshl_b32 s30, s25, 2
    v_mov_b32 v0, s30
    v_mov_b32 v3, s89
    ds_write_b32 v0, v3 offset:48
    v_lshrrev_b32 v24, 4, v1
    v_lshrrev_b32 v25, 4, v24
    v_and_b32 v24, 15, v24
    v_and_b32 v26, 7, v24
    v_lshlrev_b32 v26, 1, v26
    v_xor_b32 v26, v26, v25
    v_lshlrev_b32 v27, 8, v24
    s_mul_i32 s30, s33, 24576
    s_add_u32 s30, s30, 1024
    v_add_u32 v27, s30, v27
    v_xor_b32 v28, 0, v26
    v_lshl_add_u32 v8, v28, 4, v27
    v_xor_b32 v28, 4, v26
    v_lshl_add_u32 v9, v28, 4, v27
    v_xor_b32 v28, 8, v26
    v_lshl_add_u32 v10, v28, 4, v27
    v_xor_b32 v28, 12, v26
    v_lshl_add_u32 v11, v28, 4, v27
    s_call_b64 s[38:39], S_g
    s_waitcnt lgkmcnt(0)
    s_mov_b64 exec, 1
    ds_add_u32 v2, v4 offset:8
    s_mov_b64 exec, -1
    s_add_u32 s43, s43, 4
L_p_3:
    ds_read_b32 v3, v2 offset:8
    s_waitcnt lgkmcnt(0)
    v_readfirstlane_b32 s31, v3
    s_cmp_ge_u32 s31, s43
    s_cbranch_scc1 L_q_4
    s_branch L_p_3
L_q_4:
    v_add_u32 v252, s41, v1
    v_add_u32 v253, s42, v1
    s_cmp_eq_u32 s33, 1
    s_cbranch_scc1 L_x1b
    ds_write_b128 v252, v[60:63] offset:0
    ds_write_b128 v252, v[64:67] offset:1024
    ds_write_b128 v252, v[68:71] offset:2048
    ds_write_b128 v252, v[72:75] offset:3072
    ds_write_b128 v252, v[76:79] offset:4096
    ds_write_b128 v252, v[80:83] offset:5120
    ds_write_b128 v252, v[84:87] offset:6144
    ds_write_b128 v252, v[88:91] offset:7168
    ds_write_b128 v252, v[92:95] offset:8192
    ds_write_b128 v252, v[96:99] offset:9216
    ds_write_b128 v252, v[100:103] offset:10240
    ds_write_b128 v252, v[104:107] offset:11264
    s_branch L_x1c
L_x1b:
    ds_write_b128 v252, v[12:15] offset:0
    ds_write_b128 v252, v[16:19] offset:1024
    ds_write_b128 v252, v[20:23] offset:2048
    ds_write_b128 v252, v[24:27] offset:3072
    ds_write_b128 v252, v[28:31] offset:4096
    ds_write_b128 v252, v[32:35] offset:5120
    ds_write_b128 v252, v[36:39] offset:6144
    ds_write_b128 v252, v[40:43] offset:7168
    ds_write_b128 v252, v[44:47] offset:8192
    ds_write_b128 v252, v[48:51] offset:9216
    ds_write_b128 v252, v[52:55] offset:10240
    ds_write_b128 v252, v[56:59] offset:11264
    s_waitcnt lgkmcnt(0)
    v_mov_b32 v12, v60
    v_mov_b32 v13, v61
    v_mov_b32 v14, v62
    v_mov_b32 v15, v63
    v_mov_b32 v16, v64
    v_mov_b32 v17, v65
    v_mov_b32 v18, v66
    v_mov_b32 v19, v67
    v_mov_b32 v20, v68
    v_mov_b32 v21, v69
    v_mov_b32 v22, v70
    v_mov_b32 v23, v71
    v_mov_b32 v24, v72
    v_mov_b32 v25, v73
    v_mov_b32 v26, v74
    v_mov_b32 v27, v75
    v_mov_b32 v28, v76
    v_mov_b32 v29, v77
    v_mov_b32 v30, v78
    v_mov_b32 v31, v79
    v_mov_b32 v32, v80
    v_mov_b32 v33, v81
    v_mov_b32 v34, v82
    v_mov_b32 v35, v83
    v_mov_b32 v36, v84
    v_mov_b32 v37, v85
    v_mov_b32 v38, v86
    v_mov_b32 v39, v87
    v_mov_b32 v40, v88
    v_mov_b32 v41, v89
    v_mov_b32 v42, v90
    v_mov_b32 v43, v91
    v_mov_b32 v44, v92
    v_mov_b32 v45, v93
    v_mov_b32 v46, v94
    v_mov_b32 v47, v95
    v_mov_b32 v48, v96
    v_mov_b32 v49, v97
    v_mov_b32 v50, v98
    v_mov_b32 v51, v99
    v_mov_b32 v52, v100
    v_mov_b32 v53, v101
    v_mov_b32 v54, v102
    v_mov_b32 v55, v103
    v_mov_b32 v56, v104
    v_mov_b32 v57, v105
    v_mov_b32 v58, v106
    v_mov_b32 v59, v107
L_x1c:
    s_waitcnt lgkmcnt(0)
    s_mov_b64 exec, 1
    ds_add_u32 v2, v4 offset:8
    s_mov_b64 exec, -1
    s_add_u32 s43, s43, 4
L_p_5:
    ds_read_b32 v3, v2 offset:8
    s_waitcnt lgkmcnt(0)
    v_readfirstlane_b32 s31, v3
    s_cmp_ge_u32 s31, s43
    s_cbranch_scc1 L_q_6
    s_branch L_p_5
L_q_6:
    ds_read_b128 v[60:63], v253 offset:0
    ds_read_b128 v[64:67], v253 offset:1024
    ds_read_b128 v[68:71], v253 offset:2048
    ds_read_b128 v[72:75], v253 offset:3072
    ds_read_b128 v[76:79], v253 offset:4096
    ds_read_b128 v[80:83], v253 offset:5120
    ds_read_b128 v[84:87], v253 offset:6144
    ds_read_b128 v[88:91], v253 offset:7168
    ds_read_b128 v[92:95], v253 offset:8192
    ds_read_b128 v[96:99], v253 offset:9216
    ds_read_b128 v[100:103], v253 offset:10240
    ds_read_b128 v[104:107], v253 offset:11264
    v_lshrrev_b32 v8, 4, v1
    v_lshrrev_b32 v9, 4, v8
    v_and_b32 v8, 15, v8
    v_lshlrev_b32 v9, 9, v9
    v_lshl_add_u32 v9, v8, 3, v9
    v_add_u32 v9, s42, v9
    s_lshl_b32 s30, s32, 2
    s_lshl_b32 s31, s55, 3
    s_add_u32 s30, s30, s31
    v_mov_b32 v10, s30
    s_waitcnt lgkmcnt(11)
    v_add_f32 v12, v12, v60
    v_add_f32 v13, v13, v61
    v_add_f32 v14, v14, v62
    v_add_f32 v15, v15, v63
    s_waitcnt lgkmcnt(10)
    v_add_f32 v16, v16, v64
    v_add_f32 v17, v17, v65
    v_add_f32 v18, v18, v66
    v_add_f32 v19, v19, v67
    s_waitcnt lgkmcnt(9)
    v_add_f32 v20, v20, v68
    v_add_f32 v21, v21, v69
    v_add_f32 v22, v22, v70
    v_add_f32 v23, v23, v71
    s_waitcnt lgkmcnt(8)
    v_add_f32 v24, v24, v72
    v_add_f32 v25, v25, v73
    v_add_f32 v26, v26, v74
    v_add_f32 v27, v27, v75
    s_waitcnt lgkmcnt(7)
    v_add_f32 v28, v28, v76
    v_add_f32 v29, v29, v77
    v_add_f32 v30, v30, v78
    v_add_f32 v31, v31, v79
    s_waitcnt lgkmcnt(6)
    v_add_f32 v32, v32, v80
    v_add_f32 v33, v33, v81
    v_add_f32 v34, v34, v82
    v_add_f32 v35, v35, v83
    s_waitcnt lgkmcnt(5)
    v_add_f32 v36, v36, v84
    v_add_f32 v37, v37, v85
    v_add_f32 v38, v38, v86
    v_add_f32 v39, v39, v87
    s_waitcnt lgkmcnt(4)
    v_add_f32 v40, v40, v88
    v_add_f32 v41, v41, v89
    v_add_f32 v42, v42, v90
    v_add_f32 v43, v43, v91
    s_waitcnt lgkmcnt(3)
    v_add_f32 v44, v44, v92
    v_add_f32 v45, v45, v93
    v_add_f32 v46, v46, v94
    v_add_f32 v47, v47, v95
    s_waitcnt lgkmcnt(2)
    v_add_f32 v48, v48, v96
    v_add_f32 v49, v49, v97
    v_add_f32 v50, v50, v98
    v_add_f32 v51, v51, v99
    s_waitcnt lgkmcnt(1)
    v_add_f32 v52, v52, v100
    v_add_f32 v53, v53, v101
    v_add_f32 v54, v54, v102
    v_add_f32 v55, v55, v103
    s_waitcnt lgkmcnt(0)
    v_add_f32 v56, v56, v104
    v_add_f32 v57, v57, v105
    v_add_f32 v58, v58, v106
    v_add_f32 v59, v59, v107
    v_cvt_pk_bf16_f32 v60, v12, v24
    v_cvt_pk_bf16_f32 v61, v36, v48
    ds_write_b64 v9, v[60:61] offset:0
    v_cvt_pk_bf16_f32 v62, v13, v25
    v_cvt_pk_bf16_f32 v63, v37, v49
    ds_write_b64 v9, v[62:63] offset:128
    v_cvt_pk_bf16_f32 v64, v14, v26
    v_cvt_pk_bf16_f32 v65, v38, v50
    ds_write_b64 v9, v[64:65] offset:256
    v_cvt_pk_bf16_f32 v66, v15, v27
    v_cvt_pk_bf16_f32 v67, v39, v51
    ds_write_b64 v9, v[66:67] offset:384
    v_cvt_pk_bf16_f32 v68, v16, v28
    v_cvt_pk_bf16_f32 v69, v40, v52
    ds_write_b64 v9, v[68:69] offset:2048
    v_cvt_pk_bf16_f32 v70, v17, v29
    v_cvt_pk_bf16_f32 v71, v41, v53
    ds_write_b64 v9, v[70:71] offset:2176
    v_cvt_pk_bf16_f32 v72, v18, v30
    v_cvt_pk_bf16_f32 v73, v42, v54
    ds_write_b64 v9, v[72:73] offset:2304
    v_cvt_pk_bf16_f32 v74, v19, v31
    v_cvt_pk_bf16_f32 v75, v43, v55
    ds_write_b64 v9, v[74:75] offset:2432
    v_cvt_pk_bf16_f32 v76, v20, v32
    v_cvt_pk_bf16_f32 v77, v44, v56
    ds_write_b64 v9, v[76:77] offset:4096
    v_cvt_pk_bf16_f32 v78, v21, v33
    v_cvt_pk_bf16_f32 v79, v45, v57
    ds_write_b64 v9, v[78:79] offset:4224
    v_cvt_pk_bf16_f32 v80, v22, v34
    v_cvt_pk_bf16_f32 v81, v46, v58
    ds_write_b64 v9, v[80:81] offset:4352
    v_cvt_pk_bf16_f32 v82, v23, v35
    v_cvt_pk_bf16_f32 v83, v47, v59
    ds_write_b64 v9, v[82:83] offset:4480
    s_waitcnt lgkmcnt(0)
    s_mov_b64 exec, 1
    ds_add_u32 v10, v4 offset:32
    s_mov_b64 exec, -1
    s_cmp_eq_u32 s55, 1
    s_cbranch_scc1 G_qd
    s_setprio 0
    s_mov_b32 s55, 1
    s_add_u32 s44, s4, s34
    s_addc_u32 s45, s5, 0
    s_add_u32 s48, s10, s35
    s_addc_u32 s49, s11, 0
    s_call_b64 s[38:39], S_w
L_p_7:
    ds_read_b32 v3, v2 offset:4
    s_waitcnt lgkmcnt(0)
    v_readfirstlane_b32 s31, v3
    s_cmp_ge_u32 s31, 2
    s_cbranch_scc1 L_q_8
    s_sleep 1
    s_branch L_p_7
L_q_8:
    s_branch G_q
G_qd:
    s_setprio 2
    s_mov_b32 s55, 1
    s_mov_b32 s57, 1
G_oset:
    s_mov_b32 s52, 0x05040100
    s_mov_b32 s53, 0x07060302
    v_lshrrev_b32 v8, 4, v1
    v_and_b32 v9, 15, v8
    v_lshrrev_b32 v8, 4, v8
    v_lshlrev_b32 v8, 12, v8
    v_lshl_add_u32 v5, v9, 4, v8
    s_lshl_b32 s33, s29, 17
    s_lshl_b32 s30, s25, 8
    s_add_u32 s33, s33, s30
    s_cmp_eq_u32 s55, 0
    s_cselect_b32 s48, s12, s80
    s_cselect_b32 s49, s13, s81
    s_mov_b32 s56, 50176
    s_cselect_b32 s56, 1024, s56
    s_mov_b32 s86, 49152
    s_cselect_b32 s86, 24576, s86
    s_mov_b32 s87, 64
    s_cselect_b32 s87, 72, s87
    s_add_u32 s88, s87, 4
    s_add_u32 s48, s48, s33
    s_addc_u32 s49, s49, 0
    s_mov_b32 s50, 261376
    s_mov_b32 s51, 0x20000
    s_mov_b32 s83, 1024
    s_mov_b32 s84, 13312
    s_mov_b32 s85, 13312
    s_call_b64 s[38:39], S_w
    s_lshl_b32 s30, s26, 4
    s_lshr_b32 s31, s29, 1
    s_add_u32 s30, s30, s31
    s_lshl_b32 s31, s55, 8
    s_add_u32 s30, s30, s31
    s_mul_i32 s30, s30, 49152
    s_mul_i32 s31, s25, 12288
    s_add_u32 s30, s30, s31
    s_add_u32 s44, s20, s30
    s_addc_u32 s45, s21, 0
    s_mov_b32 s46, 12288
    s_mov_b32 s47, 0x20000
    s_mov_b32 s89, 1
    s_cmp_eq_u32 s55, 0
    s_cbranch_scc1 G_t1
L_p_9:
    ds_read_b32 v3, v2 offset:12
    s_waitcnt lgkmcnt(0)
    v_readfirstlane_b32 s31, v3
    s_cmp_ge_u32 s31, 44
    s_cbranch_scc1 L_q_10
    s_sleep 32
    s_branch L_p_9
L_q_10:
    v_lshrrev_b32 v8, 8, v1
    v_lshlrev_b32 v8, 10, v8
    v_and_b32 v9, 0xf0, v1
    v_add_u32 v8, v8, v9
    s_add_u32 s60, s12, s33
    s_addc_u32 s61, s13, 0
    s_mov_b32 s62, 261376
    s_mov_b32 s63, 0x20000
    s_lshl_b32 s30, s26, 14
    buffer_load_dwordx4 v[12:15], v8, s[60:63], s30 offen
    s_add_u32 s30, s30, 4096
    buffer_load_dwordx4 v[16:19], v8, s[60:63], s30 offen
    s_add_u32 s30, s30, 4096
    buffer_load_dwordx4 v[20:23], v8, s[60:63], s30 offen
    s_add_u32 s30, s30, 4096
    buffer_load_dwordx4 v[24:27], v8, s[60:63], s30 offen
    s_add_u32 s30, s30, 4096
    s_lshl_b32 s30, s26, 13
    s_add_u32 s30, s30, 0x20000
    buffer_load_dwordx4 v[28:31], v8, s[48:51], s30 offen
    s_add_u32 s30, s30, 4096
    buffer_load_dwordx4 v[32:35], v8, s[48:51], s30 offen
    s_add_u32 s30, s30, 4096
    s_waitcnt vmcnt(0)
G_t1:
    v_add_u32 v8, s56, v1
    v_add_u32 v9, 1024, v8
    v_add_u32 v10, 2048, v8
    v_add_u32 v11, 3072, v8
    s_call_b64 s[38:39], S_g
    v_cvt_pk_bf16_f32 v108, v12, v24
    v_cvt_pk_bf16_f32 v109, v36, v48
    v_cvt_pk_bf16_f32 v110, v60, v72
    v_cvt_pk_bf16_f32 v111, v84, v96
    s_mov_b32 s30, 0
    buffer_store_dwordx4 v[108:111], v1, s[44:47], s30 offen offset:0 sc0 sc1
    v_cvt_pk_bf16_f32 v112, v13, v25
    v_cvt_pk_bf16_f32 v113, v37, v49
    v_cvt_pk_bf16_f32 v114, v61, v73
    v_cvt_pk_bf16_f32 v115, v85, v97
    buffer_store_dwordx4 v[112:115], v1, s[44:47], s30 offen offset:1024 sc0 sc1
    v_cvt_pk_bf16_f32 v116, v14, v26
    v_cvt_pk_bf16_f32 v117, v38, v50
    v_cvt_pk_bf16_f32 v118, v62, v74
    v_cvt_pk_bf16_f32 v119, v86, v98
    buffer_store_dwordx4 v[116:119], v1, s[44:47], s30 offen offset:2048 sc0 sc1
    v_cvt_pk_bf16_f32 v120, v15, v27
    v_cvt_pk_bf16_f32 v121, v39, v51
    v_cvt_pk_bf16_f32 v122, v63, v75
    v_cvt_pk_bf16_f32 v123, v87, v99
    buffer_store_dwordx4 v[120:123], v1, s[44:47], s30 offen offset:3072 sc0 sc1
    v_cvt_pk_bf16_f32 v124, v16, v28
    v_cvt_pk_bf16_f32 v125, v40, v52
    v_cvt_pk_bf16_f32 v126, v64, v76
    v_cvt_pk_bf16_f32 v127, v88, v100
    s_mov_b32 s30, 4096
    buffer_store_dwordx4 v[124:127], v1, s[44:47], s30 offen offset:0 sc0 sc1
    v_cvt_pk_bf16_f32 v128, v17, v29
    v_cvt_pk_bf16_f32 v129, v41, v53
    v_cvt_pk_bf16_f32 v130, v65, v77
    v_cvt_pk_bf16_f32 v131, v89, v101
    buffer_store_dwordx4 v[128:131], v1, s[44:47], s30 offen offset:1024 sc0 sc1
    v_cvt_pk_bf16_f32 v132, v18, v30
    v_cvt_pk_bf16_f32 v133, v42, v54
    v_cvt_pk_bf16_f32 v134, v66, v78
    v_cvt_pk_bf16_f32 v135, v90, v102
    buffer_store_dwordx4 v[132:135], v1, s[44:47], s30 offen offset:2048 sc0 sc1
    v_cvt_pk_bf16_f32 v136, v19, v31
    v_cvt_pk_bf16_f32 v137, v43, v55
    v_cvt_pk_bf16_f32 v138, v67, v79
    v_cvt_pk_bf16_f32 v139, v91, v103
    buffer_store_dwordx4 v[136:139], v1, s[44:47], s30 offen offset:3072 sc0 sc1
    v_cvt_pk_bf16_f32 v140, v20, v32
    v_cvt_pk_bf16_f32 v141, v44, v56
    v_cvt_pk_bf16_f32 v142, v68, v80
    v_cvt_pk_bf16_f32 v143, v92, v104
    s_mov_b32 s30, 8192
    buffer_store_dwordx4 v[140:143], v1, s[44:47], s30 offen offset:0 sc0 sc1
    v_cvt_pk_bf16_f32 v144, v21, v33
    v_cvt_pk_bf16_f32 v145, v45, v57
    v_cvt_pk_bf16_f32 v146, v69, v81
    v_cvt_pk_bf16_f32 v147, v93, v105
    buffer_store_dwordx4 v[144:147], v1, s[44:47], s30 offen offset:1024 sc0 sc1
    v_cvt_pk_bf16_f32 v148, v22, v34
    v_cvt_pk_bf16_f32 v149, v46, v58
    v_cvt_pk_bf16_f32 v150, v70, v82
    v_cvt_pk_bf16_f32 v151, v94, v106
    buffer_store_dwordx4 v[148:151], v1, s[44:47], s30 offen offset:2048 sc0 sc1
    v_cvt_pk_bf16_f32 v152, v23, v35
    v_cvt_pk_bf16_f32 v153, v47, v59
    v_cvt_pk_bf16_f32 v154, v71, v83
    v_cvt_pk_bf16_f32 v155, v95, v107
    buffer_store_dwordx4 v[152:155], v1, s[44:47], s30 offen offset:3072 sc0 sc1
    s_add_u32 s25, s25, 2
    s_sub_u32 s57, s57, 1
    s_cmp_lg_u32 s57, 0
    s_cbranch_scc1 G_oset
    s_waitcnt vmcnt(0)
    s_lshl_b32 s30, s55, 2
    v_mov_b32 v8, s30
    s_mov_b64 exec, 1
    ds_add_rtn_u32 v3, v8, v4 offset:24
    s_waitcnt lgkmcnt(0)
    v_readfirstlane_b32 s31, v3
    s_lshl_b32 s30, s55, 1
    s_add_u32 s30, s30, 1
    s_mov_b32 s30, 3
    s_cmp_lg_u32 s31, s30
    s_cbranch_scc1 G_nf
    s_add_u32 s60, s20, 0x1800000
    s_addc_u32 s61, s21, 0
    s_mov_b32 s62, 4096
    s_mov_b32 s63, 0x20000
    s_lshl_b32 s30, s26, 7
    s_lshl_b32 s31, s29, 1
    s_add_u32 s30, s30, s31
    s_lshl_b32 s31, s55, 11
    s_add_u32 s30, s30, s31
    buffer_store_dword v4, v2, s[60:63], s30 offen sc0 sc1
G_nf:
    s_mov_b64 exec, -1
    s_mov_b32 s59, s55
    s_and_b32 s37, s22, 3
    s_call_b64 s[38:39], S_red
    s_branch K_end
R_att:
    v_and_b32 v252, 15, v0
    v_lshrrev_b32 v253, 4, v0
    v_lshlrev_b32 v255, 8, v253
    v_lshlrev_b32 v254, 1, v253
    v_xor_b32 v254, v254, v252
    v_xor_b32 v24, 0, v254
    v_lshl_add_u32 v5, v24, 4, v255
    v_xor_b32 v24, 8, v254
    v_lshl_add_u32 v6, v24, 4, v255
    s_mov_b32 s38, 262144
    s_mov_b32 s39, 0x20000
    s_mov_b32 s42, 262144
    s_mov_b32 s43, 0x20000
    s_mov_b32 s51, 0
    s_mov_b32 s52, 0
    s_mov_b32 s53, 0
    s_mov_b32 s54, 0
    s_mov_b32 s57, 0
    s_mov_b32 s58, 0
    s_mov_b32 s61, 0
    s_mov_b32 s66, 0
    s_mov_b32 s46, 0
    s_and_b32 s30, s22, 1
    s_lshl_b32 s32, s26, 5
    s_add_u32 s32, s32, s29
    s_add_u32 s32, s32, s30
    s_cmp_ge_u32 s22, 2
    s_cbranch_scc1 L_setA
    s_setprio 1
    s_lshl_b32 s33, s32, 18
    s_add_u32 s36, s74, s33
    s_addc_u32 s37, s75, 0
    s_add_u32 s40, s76, s33
    s_addc_u32 s41, s77, 0
    s_mul_i32 s55, s22, 49152
    s_add_u32 s55, s55, 50176
    s_add_u32 s56, s55, 24576
    s_mov_b32 s64, 24576
    s_mov_b32 s65, 24576
    s_mul_i32 s51, s32, 5
    s_lshr_b32 s30, s32, 4
    s_mul_i32 s30, s30, 7
    s_add_u32 s51, s51, s30
    s_and_b32 s51, s51, 31
    s_lshl_b32 s51, s51, 13
    s_mov_b32 s52, s51
    s_mov_b32 s44, 31
    s_mov_b32 s45, 31
L_p_11:
    ds_read_b32 v3, v2 offset:20
    s_waitcnt lgkmcnt(0)
    v_readfirstlane_b32 s31, v3
    s_cmp_ge_u32 s31, 6
    s_cbranch_scc1 L_q_12
    s_sleep 1
    s_branch L_p_11
L_q_12:
    s_add_u32 m0, s53, s55
    s_nop 0
    buffer_load_dwordx4 v5, s[36:39], s51 offen offset:0 nt lds
    buffer_load_dwordx4 v6, s[36:39], s51 offen offset:1024 nt lds
    buffer_load_dwordx4 v5, s[36:39], s51 offen offset:2048 nt lds
    buffer_load_dwordx4 v6, s[36:39], s51 offen offset:3072 nt lds
    s_add_u32 m0, m0, 4096
    s_add_u32 s51, s51, 4096
    buffer_load_dwordx4 v5, s[36:39], s51 offen offset:0 nt lds
    buffer_load_dwordx4 v6, s[36:39], s51 offen offset:1024 nt lds
    buffer_load_dwordx4 v5, s[36:39], s51 offen offset:2048 nt lds
    buffer_load_dwordx4 v6, s[36:39], s51 offen offset:3072 nt lds
    s_add_u32 s51, s51, 4096
    s_and_b32 s51, s51, 0x3ffff
    s_sub_u32 s44, s44, 1
    s_cselect_b32 s38, 0, s38
    s_add_u32 s53, s53, 8192
    s_cmp_eq_u32 s53, s64
    s_cselect_b32 s53, 0, s53
    s_add_u32 m0, s53, s55
    s_nop 0
    buffer_load_dwordx4 v5, s[36:39], s51 offen offset:0 nt lds
    buffer_load_dwordx4 v6, s[36:39], s51 offen offset:1024 nt lds
    buffer_load_dwordx4 v5, s[36:39], s51 offen offset:2048 nt lds
    buffer_load_dwordx4 v6, s[36:39], s51 offen offset:3072 nt lds
    s_add_u32 m0, m0, 4096
    s_add_u32 s51, s51, 4096
    buffer_load_dwordx4 v5, s[36:39], s51 offen offset:0 nt lds
    buffer_load_dwordx4 v6, s[36:39], s51 offen offset:1024 nt lds
    buffer_load_dwordx4 v5, s[36:39], s51 offen offset:2048 nt lds
    buffer_load_dwordx4 v6, s[36:39], s51 offen offset:3072 nt lds
    s_add_u32 s51, s51, 4096
    s_and_b32 s51, s51, 0x3ffff
    s_sub_u32 s44, s44, 1
    s_cselect_b32 s38, 0, s38
    s_add_u32 s53, s53, 8192
    s_cmp_eq_u32 s53, s64
    s_cselect_b32 s53, 0, s53
    s_add_u32 m0, s54, s56
    s_nop 0
    buffer_load_dwordx4 v5, s[40:43], s52 offen offset:0 nt lds
    buffer_load_dwordx4 v6, s[40:43], s52 offen offset:1024 nt lds
    buffer_load_dwordx4 v5, s[40:43], s52 offen offset:2048 nt lds
    buffer_load_dwordx4 v6, s[40:43], s52 offen offset:3072 nt lds
    s_add_u32 m0, m0, 4096
    s_add_u32 s52, s52, 4096
    buffer_load_dwordx4 v5, s[40:43], s52 offen offset:0 nt lds
    buffer_load_dwordx4 v6, s[40:43], s52 offen offset:1024 nt lds
    buffer_load_dwordx4 v5, s[40:43], s52 offen offset:2048 nt lds
    buffer_load_dwordx4 v6, s[40:43], s52 offen offset:3072 nt lds
    s_add_u32 s52, s52, 4096
    s_and_b32 s52, s52, 0x3ffff
    s_sub_u32 s45, s45, 1
    s_cselect_b32 s42, 0, s42
    s_add_u32 s54, s54, 8192
    s_cmp_eq_u32 s54, s65
    s_cselect_b32 s54, 0, s54
    s_add_u32 m0, s53, s55
    s_nop 0
    buffer_load_dwordx4 v5, s[36:39], s51 offen offset:0 nt lds
    buffer_load_dwordx4 v6, s[36:39], s51 offen offset:1024 nt lds
    buffer_load_dwordx4 v5, s[36:39], s51 offen offset:2048 nt lds
    buffer_load_dwordx4 v6, s[36:39], s51 offen offset:3072 nt lds
    s_add_u32 m0, m0, 4096
    s_add_u32 s51, s51, 4096
    buffer_load_dwordx4 v5, s[36:39], s51 offen offset:0 nt lds
    buffer_load_dwordx4 v6, s[36:39], s51 offen offset:1024 nt lds
    buffer_load_dwordx4 v5, s[36:39], s51 offen offset:2048 nt lds
    buffer_load_dwordx4 v6, s[36:39], s51 offen offset:3072 nt lds
    s_add_u32 s51, s51, 4096
    s_and_b32 s51, s51, 0x3ffff
    s_sub_u32 s44, s44, 1
    s_cselect_b32 s38, 0, s38
    s_add_u32 s53, s53, 8192
    s_cmp_eq_u32 s53, s64
    s_cselect_b32 s53, 0, s53
    s_add_u32 m0, s54, s56
    s_nop 0
    buffer_load_dwordx4 v5, s[40:43], s52 offen offset:0 nt lds
    buffer_load_dwordx4 v6, s[40:43], s52 offen offset:1024 nt lds
    buffer_load_dwordx4 v5, s[40:43], s52 offen offset:2048 nt lds
    buffer_load_dwordx4 v6, s[40:43], s52 offen offset:3072 nt lds
    s_add_u32 m0, m0, 4096
    s_add_u32 s52, s52, 4096
    buffer_load_dwordx4 v5, s[40:43], s52 offen offset:0 nt lds
    buffer_load_dwordx4 v6, s[40:43], s52 offen offset:1024 nt lds
    buffer_load_dwordx4 v5, s[40:43], s52 offen offset:2048 nt lds
    buffer_load_dwordx4 v6, s[40:43], s52 offen offset:3072 nt lds
    s_add_u32 s52, s52, 4096
    s_and_b32 s52, s52, 0x3ffff
    s_sub_u32 s45, s45, 1
    s_cselect_b32 s42, 0, s42
    s_add_u32 s54, s54, 8192
    s_cmp_eq_u32 s54, s65
    s_cselect_b32 s54, 0, s54
    s_mov_b32 s34, s55
    s_mov_b32 s35, s56
    s_branch L_set
L_setA:
    s_setprio 3
    s_mov_b32 s63, 0x20000
    s_and_b32 s33, s22, 1
    s_mov_b32 s60, s78
    s_mov_b32 s61, s79
    s_mov_b32 s62, 0x400000
    s_lshl_b32 s30, s24, 17
    s_lshl_b32 s31, s33, 16
    s_add_u32 s30, s30, s31
    s_lshl_b32 s31, s23, 10
    s_add_u32 s30, s30, s31
    buffer_load_dwordx4 v[24:27], v1, s[60:63], s30 offen
    s_add_u32 s30, s30, 8192
    buffer_load_dwordx4 v[28:31], v1, s[60:63], s30 offen
    s_add_u32 s30, s30, 8192
    buffer_load_dwordx4 v[32:35], v1, s[60:63], s30 offen
    s_add_u32 s30, s30, 8192
    buffer_load_dwordx4 v[36:39], v1, s[60:63], s30 offen
    s_add_u32 s30, s30, 8192
    buffer_load_dwordx4 v[40:43], v1, s[60:63], s30 offen
    s_add_u32 s30, s30, 8192
    buffer_load_dwordx4 v[44:47], v1, s[60:63], s30 offen
    s_add_u32 s30, s30, 8192
    buffer_load_dwordx4 v[48:51], v1, s[60:63], s30 offen
    s_add_u32 s30, s30, 8192
    buffer_load_dwordx4 v[52:55], v1, s[60:63], s30 offen
    s_add_u32 s30, s30, 8192
    s_waitcnt lgkmcnt(0)
    s_mov_b64 exec, 1
    ds_add_u32 v2, v4 offset:20
    s_mov_b64 exec, -1
    s_waitcnt vmcnt(0)
    s_waitcnt lgkmcnt(0)
    s_mov_b64 exec, 1
    ds_add_u32 v2, v4 offset:16
    s_mov_b64 exec, -1
    s_cmp_lg_u32 s22, 2
    s_cbranch_scc1 L_noinit
    s_add_u32 s60, s20, 0x1800000
    s_addc_u32 s61, s21, 0
    s_mov_b32 s62, 4096
    s_mov_b32 s63, 0x20000
    s_lshl_b32 s30, s26, 7
    s_lshl_b32 s31, s29, 1
    s_add_u32 s30, s30, s31
    s_mov_b64 exec, 1
    buffer_store_dword v2, v2, s[60:63], s30 offen sc0 sc1
    buffer_store_dword v2, v2, s[60:63], s30 offen offset:2048 sc0 sc1
    s_waitcnt vmcnt(0)
    s_mov_b32 s60, s18
    s_mov_b32 s61, s19
    s_mov_b32 s62, 256
    s_lshl_b32 s30, s26, 2
    buffer_atomic_add v4, v2, s[60:63], s30 offen sc1
    s_mov_b64 exec, -1
    s_waitcnt vmcnt(0)
    s_mov_b32 s61, 0
L_noinit:
    s_mov_b32 s63, 0x20000
L_p_13:
    ds_read_b32 v3, v2 offset:20
    s_waitcnt lgkmcnt(0)
    v_readfirstlane_b32 s31, v3
    s_cmp_ge_u32 s31, 6
    s_cbranch_scc1 L_q_14
    s_sleep 2
    s_branch L_p_13
L_q_14:
    s_mov_b32 s60, s10
    s_mov_b32 s61, s11
    s_mov_b32 s62, 0x400000
    s_lshl_b32 s30, s24, 17
    s_lshl_b32 s31, s33, 16
    s_add_u32 s30, s30, s31
    s_lshl_b32 s31, s23, 10
    s_add_u32 s30, s30, s31
    buffer_load_dwordx4 v[24:27], v1, s[60:63], s30 offen
    s_add_u32 s30, s30, 8192
    buffer_load_dwordx4 v[28:31], v1, s[60:63], s30 offen
    s_add_u32 s30, s30, 8192
    buffer_load_dwordx4 v[32:35], v1, s[60:63], s30 offen
    s_add_u32 s30, s30, 8192
    buffer_load_dwordx4 v[36:39], v1, s[60:63], s30 offen
    s_add_u32 s30, s30, 8192
    buffer_load_dwordx4 v[40:43], v1, s[60:63], s30 offen
    s_add_u32 s30, s30, 8192
    buffer_load_dwordx4 v[44:47], v1, s[60:63], s30 offen
    s_add_u32 s30, s30, 8192
    buffer_load_dwordx4 v[48:51], v1, s[60:63], s30 offen
    s_add_u32 s30, s30, 8192
    buffer_load_dwordx4 v[52:55], v1, s[60:63], s30 offen
    s_add_u32 s30, s30, 8192
    s_waitcnt vmcnt(0)
    s_mov_b32 s61, 0
    s_setprio 2
    s_lshl_b32 s33, s26, 3
    s_add_u32 s33, s33, s23
    s_mul_i32 s51, s33, 5
    s_lshr_b32 s30, s33, 4
    s_mul_i32 s30, s30, 7
    s_add_u32 s51, s51, s30
    s_and_b32 s51, s51, 31
    s_lshl_b32 s51, s51, 13
    s_mov_b32 s52, s51
    s_mov_b32 s44, 31
    s_mov_b32 s45, 31
    s_lshl_b32 s33, s33, 18
    s_cmp_eq_u32 s22, 3
    s_cselect_b32 s36, s8, s6
    s_cselect_b32 s37, s9, s7
    s_mov_b32 s34, 1024
    s_mov_b32 s35, 25600
    s_mov_b32 s64, 24576
    s_mov_b32 s65, 24576
    s_cselect_b32 s55, s35, s34
    s_add_u32 s36, s36, s33
    s_addc_u32 s37, s37, 0
    s_mov_b32 s40, s36
    s_mov_b32 s41, s37
    s_mov_b32 s56, s55
    buffer_load_dwordx4 v[28:31], v5, s[36:39], s51 offen offset:0
    buffer_load_dwordx4 v[32:35], v6, s[36:39], s51 offen offset:1024
    buffer_load_dwordx4 v[36:39], v5, s[36:39], s51 offen offset:2048
    buffer_load_dwordx4 v[40:43], v6, s[36:39], s51 offen offset:3072
    s_add_u32 s51, s51, 4096
    buffer_load_dwordx4 v[44:47], v5, s[36:39], s51 offen offset:0
    buffer_load_dwordx4 v[48:51], v6, s[36:39], s51 offen offset:1024
    buffer_load_dwordx4 v[52:55], v5, s[36:39], s51 offen offset:2048
    buffer_load_dwordx4 v[56:59], v6, s[36:39], s51 offen offset:3072
    s_add_u32 s51, s51, 4096
    s_and_b32 s51, s51, 0x3ffff
    s_sub_u32 s44, s44, 1
    buffer_load_dwordx4 v[60:63], v5, s[36:39], s51 offen offset:0
    buffer_load_dwordx4 v[64:67], v6, s[36:39], s51 offen offset:1024
    buffer_load_dwordx4 v[68:71], v5, s[36:39], s51 offen offset:2048
    buffer_load_dwordx4 v[72:75], v6, s[36:39], s51 offen offset:3072
    s_add_u32 s51, s51, 4096
    buffer_load_dwordx4 v[76:79], v5, s[36:39], s51 offen offset:0
    buffer_load_dwordx4 v[80:83], v6, s[36:39], s51 offen offset:1024
    buffer_load_dwordx4 v[84:87], v5, s[36:39], s51 offen offset:2048
    buffer_load_dwordx4 v[88:91], v6, s[36:39], s51 offen offset:3072
    s_add_u32 s51, s51, 4096
    s_and_b32 s51, s51, 0x3ffff
    s_sub_u32 s44, s44, 1
    buffer_load_dwordx4 v[92:95], v5, s[36:39], s51 offen offset:0
    buffer_load_dwordx4 v[96:99], v6, s[36:39], s51 offen offset:1024
    buffer_load_dwordx4 v[100:103], v5, s[36:39], s51 offen offset:2048
    buffer_load_dwordx4 v[104:107], v6, s[36:39], s51 offen offset:3072
    s_add_u32 s51, s51, 4096
    buffer_load_dwordx4 v[108:111], v5, s[36:39], s51 offen offset:0
    buffer_load_dwordx4 v[112:115], v6, s[36:39], s51 offen offset:1024
    buffer_load_dwordx4 v[116:119], v5, s[36:39], s51 offen offset:2048
    buffer_load_dwordx4 v[120:123], v6, s[36:39], s51 offen offset:3072
    s_add_u32 s51, s51, 4096
    s_and_b32 s51, s51, 0x3ffff
    s_sub_u32 s44, s44, 1
L_set:
    s_mov_b32 s48, 0x3e0293ee
    s_mov_b32 s49, 0x41000000
    v_and_b32 v254, 7, v252
    v_lshlrev_b32 v254, 1, v254
    v_xor_b32 v254, v254, v253
    v_lshlrev_b32 v255, 8, v252
    v_add_u32 v255, s34, v255
    v_xor_b32 v24, 0, v254
    v_lshl_add_u32 v8, v24, 4, v255
    v_xor_b32 v24, 4, v254
    v_lshl_add_u32 v9, v24, 4, v255
    v_xor_b32 v24, 8, v254
    v_lshl_add_u32 v10, v24, 4, v255
    v_xor_b32 v24, 12, v254
    v_lshl_add_u32 v11, v24, 4, v255
    v_lshrrev_b32 v254, 2, v252
    v_lshl_add_u32 v254, v253, 2, v254
    v_and_b32 v255, 3, v252
    v_lshlrev_b32 v255, 3, v255
    v_lshl_add_u32 v255, v254, 8, v255
    v_add_u32 v255, s35, v255
    v_and_b32 v254, 7, v254
    v_xor_b32 v24, 0, v254
    v_lshl_add_u32 v12, v24, 5, v255
    v_xor_b32 v24, 1, v254
    v_lshl_add_u32 v13, v24, 5, v255
    v_xor_b32 v24, 2, v254
    v_lshl_add_u32 v14, v24, 5, v255
    v_xor_b32 v24, 3, v254
    v_lshl_add_u32 v15, v24, 5, v255
    v_xor_b32 v24, 4, v254
    v_lshl_add_u32 v16, v24, 5, v255
    v_xor_b32 v24, 5, v254
    v_lshl_add_u32 v17, v24, 5, v255
    v_xor_b32 v24, 6, v254
    v_lshl_add_u32 v18, v24, 5, v255
    v_xor_b32 v24, 7, v254
    v_lshl_add_u32 v19, v24, 5, v255
    v_mov_b32 v204, 0x3f803f80
    v_mov_b32 v205, 0x3f803f80
    v_mov_b32 v206, 0x3f803f80
    v_mov_b32 v207, 0x3f803f80
    s_cmp_ge_u32 s22, 2
    s_cbranch_scc1 L_nz
    v_mov_b32 v24, 0
    v_mov_b32 v25, 0
    v_mov_b32 v26, 0
    v_mov_b32 v27, 0
    v_mov_b32 v28, 0
    v_mov_b32 v29, 0
    v_mov_b32 v30, 0
    v_mov_b32 v31, 0
    v_mov_b32 v32, 0
    v_mov_b32 v33, 0
    v_mov_b32 v34, 0
    v_mov_b32 v35, 0
    v_mov_b32 v36, 0
    v_mov_b32 v37, 0
    v_mov_b32 v38, 0
    v_mov_b32 v39, 0
    v_mov_b32 v40, 0
    v_mov_b32 v41, 0
    v_mov_b32 v42, 0
    v_mov_b32 v43, 0
    v_mov_b32 v44, 0
    v_mov_b32 v45, 0
    v_mov_b32 v46, 0
    v_mov_b32 v47, 0
    v_mov_b32 v48, 0
    v_mov_b32 v49, 0
    v_mov_b32 v50, 0
    v_mov_b32 v51, 0
    v_mov_b32 v52, 0
    v_mov_b32 v53, 0
    v_mov_b32 v54, 0
    v_mov_b32 v55, 0
    v_mov_b32 v56, 0
    v_mov_b32 v57, 0
    v_mov_b32 v58, 0
    v_mov_b32 v59, 0
    v_mov_b32 v60, 0
    v_mov_b32 v61, 0
    v_mov_b32 v62, 0
    v_mov_b32 v63, 0
    v_mov_b32 v64, 0
    v_mov_b32 v65, 0
    v_mov_b32 v66, 0
    v_mov_b32 v67, 0
    v_mov_b32 v68, 0
    v_mov_b32 v69, 0
    v_mov_b32 v70, 0
    v_mov_b32 v71, 0
    v_mov_b32 v72, 0
    v_mov_b32 v73, 0
    v_mov_b32 v74, 0
    v_mov_b32 v75, 0
    v_mov_b32 v76, 0
    v_mov_b32 v77, 0
    v_mov_b32 v78, 0
    v_mov_b32 v79, 0
    v_mov_b32 v80, 0
    v_mov_b32 v81, 0
    v_mov_b32 v82, 0
    v_mov_b32 v83, 0
    v_mov_b32 v84, 0
    v_mov_b32 v85, 0
    v_mov_b32 v86, 0
    v_mov_b32 v87, 0
    v_mov_b32 v88, 0
    v_mov_b32 v89, 0
    v_mov_b32 v90, 0
    v_mov_b32 v91, 0
    v_mov_b32 v92, 0
    v_mov_b32 v93, 0
    v_mov_b32 v94, 0
    v_mov_b32 v95, 0
    v_mov_b32 v96, 0
    v_mov_b32 v97, 0
    v_mov_b32 v98, 0
    v_mov_b32 v99, 0
    v_mov_b32 v100, 0
    v_mov_b32 v101, 0
    v_mov_b32 v102, 0
    v_mov_b32 v103, 0
    v_mov_b32 v104, 0
    v_mov_b32 v105, 0
    v_mov_b32 v106, 0
    v_mov_b32 v107, 0
    v_mov_b32 v108, 0
    v_mov_b32 v109, 0
    v_mov_b32 v110, 0
    v_mov_b32 v111, 0
    v_mov_b32 v112, 0
    v_mov_b32 v113, 0
    v_mov_b32 v114, 0
    v_mov_b32 v115, 0
    v_mov_b32 v116, 0
    v_mov_b32 v117, 0
    v_mov_b32 v118, 0
    v_mov_b32 v119, 0
    v_mov_b32 v120, 0
    v_mov_b32 v121, 0
    v_mov_b32 v122, 0
    v_mov_b32 v123, 0
    v_mov_b32 v124, 0
    v_mov_b32 v125, 0
    v_mov_b32 v126, 0
    v_mov_b32 v127, 0
    v_mov_b32 v128, 0
    v_mov_b32 v129, 0
    v_mov_b32 v130, 0
    v_mov_b32 v131, 0
L_nz:
    v_mov_b32 v20, 0
    v_mov_b32 v21, 0
    v_mov_b32 v22, 0
    s_mov_b32 s50, 1
    s_lshl_b32 s30, s22, 2
    v_mov_b32 v7, s30
L_wq:
    ds_read_b32 v3, v7 offset:32
    s_waitcnt lgkmcnt(0)
    v_readfirstlane_b32 s31, v3
    s_cmp_ge_u32 s31, 2
    s_cbranch_scc1 L_wq2
    s_sleep 2
    s_branch L_wq
L_wq2:
    s_and_b32 s30, s22, 1
    s_mul_i32 s30, s30, 12288
    v_lshrrev_b32 v7, 1, v1
    v_add_u32 v7, s30, v7
    ds_read_b64 v[156:157], v7 offset:25600
    ds_read_b64 v[158:159], v7 offset:1024
    ds_read_b64 v[160:161], v7 offset:26112
    ds_read_b64 v[162:163], v7 offset:1536
    ds_read_b64 v[164:165], v7 offset:26624
    ds_read_b64 v[166:167], v7 offset:2048
    ds_read_b64 v[168:169], v7 offset:27136
    ds_read_b64 v[170:171], v7 offset:2560
    ds_read_b64 v[172:173], v7 offset:27648
    ds_read_b64 v[174:175], v7 offset:3072
    ds_read_b64 v[176:177], v7 offset:28160
    ds_read_b64 v[178:179], v7 offset:3584
    ds_read_b64 v[180:181], v7 offset:28672
    ds_read_b64 v[182:183], v7 offset:4096
    s_waitcnt lgkmcnt(4)
    ds_read_b64 v[184:185], v7 offset:29184
    ds_read_b64 v[186:187], v7 offset:4608
    ds_read_b64 v[188:189], v7 offset:29696
    ds_read_b64 v[190:191], v7 offset:5120
    ds_read_b64 v[192:193], v7 offset:30208
    ds_read_b64 v[194:195], v7 offset:5632
    ds_read_b64 v[196:197], v7 offset:30720
    ds_read_b64 v[198:199], v7 offset:6144
    ds_read_b64 v[200:201], v7 offset:31232
    ds_read_b64 v[202:203], v7 offset:6656
    s_waitcnt lgkmcnt(0)
    s_mov_b64 exec, 1
    ds_add_u32 v2, v4 offset:4
    s_mov_b64 exec, -1
    s_cmp_ge_u32 s22, 2
    s_cbranch_scc1 L_runA
    s_lshl_b32 s30, s22, 2
    v_mov_b32 v7, s30
    s_waitcnt vmcnt(32)
    ds_read_b128 v[208:211], v8 offset:0
    ds_read_b128 v[212:215], v9 offset:0
    ds_read_b128 v[216:219], v10 offset:0
    ds_read_b128 v[220:223], v11 offset:0
    ds_read_b128 v[224:227], v8 offset:4096
    ds_read_b128 v[228:231], v9 offset:4096
    ds_read_b128 v[232:235], v10 offset:4096
    ds_read_b128 v[236:239], v11 offset:4096
    s_mov_b32 s59, s57
    s_add_u32 s57, s57, 8192
    s_cmp_eq_u32 s57, s64
    s_cselect_b32 s57, 0, s57
    s_sub_u32 s59, s57, s59
    s_waitcnt lgkmcnt(7)
    v_mfma_f32_16x16x32_bf16 v[132:135], v[208:211], v[156:159], 0
    v_mfma_f32_16x16x32_bf16 v[136:139], v[208:211], v[172:175], 0
    v_mfma_f32_16x16x32_bf16 v[140:143], v[208:211], v[188:191], 0
    s_waitcnt lgkmcnt(6)
    v_mfma_f32_16x16x32_bf16 v[132:135], v[212:215], v[160:163], v[132:135]
    v_mfma_f32_16x16x32_bf16 v[136:139], v[212:215], v[176:179], v[136:139]
    v_mfma_f32_16x16x32_bf16 v[140:143], v[212:215], v[192:195], v[140:143]
    s_waitcnt lgkmcnt(5)
    v_mfma_f32_16x16x32_bf16 v[132:135], v[216:219], v[164:167], v[132:135]
    v_mfma_f32_16x16x32_bf16 v[136:139], v[216:219], v[180:183], v[136:139]
    v_mfma_f32_16x16x32_bf16 v[140:143], v[216:219], v[196:199], v[140:143]
    s_waitcnt lgkmcnt(4)
    v_mfma_f32_16x16x32_bf16 v[132:135], v[220:223], v[168:171], v[132:135]
    v_mfma_f32_16x16x32_bf16 v[136:139], v[220:223], v[184:187], v[136:139]
    v_mfma_f32_16x16x32_bf16 v[140:143], v[220:223], v[200:203], v[140:143]
    s_waitcnt lgkmcnt(0)
    s_cmp_eq_u32 s66, 0
    s_cbranch_scc1 L_th_15
    s_waitcnt vmcnt(6)
L_th_15:
    s_add_u32 m0, s53, s55
    s_nop 0
    buffer_load_dwordx4 v5, s[36:39], s51 offen offset:0 nt lds
    buffer_load_dwordx4 v6, s[36:39], s51 offen offset:1024 nt lds
    s_waitcnt lgkmcnt(3)
    v_mfma_f32_16x16x32_bf16 v[144:147], v[224:227], v[156:159], 0
    v_add_u32 v8, s59, v8
    v_mfma_f32_16x16x32_bf16 v[148:151], v[224:227], v[172:175], 0
    v_add_u32 v9, s59, v9
    v_mfma_f32_16x16x32_bf16 v[152:155], v[224:227], v[188:191], 0
    v_add_u32 v10, s59, v10
    v_add_u32 v11, s59, v11
    buffer_load_dwordx4 v5, s[36:39], s51 offen offset:2048 nt lds
    buffer_load_dwordx4 v6, s[36:39], s51 offen offset:3072 nt lds
    s_waitcnt lgkmcnt(2)
    v_mfma_f32_16x16x32_bf16 v[144:147], v[228:231], v[160:163], v[144:147]
    v_fma_f32 v132, v132, s48, -v20
    v_fma_f32 v133, v133, s48, -v20
    v_mfma_f32_16x16x32_bf16 v[148:151], v[228:231], v[176:179], v[148:151]
    v_fma_f32 v134, v134, s48, -v20
    v_fma_f32 v135, v135, s48, -v20
    v_mfma_f32_16x16x32_bf16 v[152:155], v[228:231], v[192:195], v[152:155]
    v_fma_f32 v136, v136, s48, -v21
    v_max3_f32 v252, v132, v133, v134
    s_add_u32 m0, m0, 4096
    s_add_u32 s51, s51, 4096
    buffer_load_dwordx4 v5, s[36:39], s51 offen offset:0 nt lds
    buffer_load_dwordx4 v6, s[36:39], s51 offen offset:1024 nt lds
    s_waitcnt lgkmcnt(1)
    v_mfma_f32_16x16x32_bf16 v[144:147], v[232:235], v[164:167], v[144:147]
    v_fma_f32 v137, v137, s48, -v21
    v_fma_f32 v138, v138, s48, -v21
    v_mfma_f32_16x16x32_bf16 v[148:151], v[232:235], v[180:183], v[148:151]
    v_max3_f32 v252, v252, v135, v136
    v_fma_f32 v139, v139, s48, -v21
    v_mfma_f32_16x16x32_bf16 v[152:155], v[232:235], v[196:199], v[152:155]
    v_fma_f32 v140, v140, s48, -v22
    v_max3_f32 v252, v252, v137, v138
    buffer_load_dwordx4 v5, s[36:39], s51 offen offset:2048 nt lds
    buffer_load_dwordx4 v6, s[36:39], s51 offen offset:3072 nt lds
    s_waitcnt lgkmcnt(0)
    v_mfma_f32_16x16x32_bf16 v[144:147], v[236:239], v[168:171], v[144:147]
    v_fma_f32 v141, v141, s48, -v22
    v_fma_f32 v142, v142, s48, -v22
    v_mfma_f32_16x16x32_bf16 v[148:151], v[236:239], v[184:187], v[148:151]
    v_max3_f32 v252, v252, v139, v140
    v_fma_f32 v143, v143, s48, -v22
    v_mfma_f32_16x16x32_bf16 v[152:155], v[236:239], v[200:203], v[152:155]
    v_max3_f32 v252, v252, v141, v142
    v_max_f32 v252, v252, v143
    s_add_u32 s51, s51, 4096
    s_and_b32 s51, s51, 0x3ffff
    s_sub_u32 s44, s44, 1
    s_cselect_b32 s38, 0, s38
    s_add_u32 s53, s53, 8192
    s_cmp_eq_u32 s53, s64
    s_cselect_b32 s53, 0, s53
    s_add_u32 m0, s54, s56
    s_nop 0
    buffer_load_dwordx4 v5, s[40:43], s52 offen offset:0 nt lds
    buffer_load_dwordx4 v6, s[40:43], s52 offen offset:1024 nt lds
    buffer_load_dwordx4 v5, s[40:43], s52 offen offset:2048 nt lds
    buffer_load_dwordx4 v6, s[40:43], s52 offen offset:3072 nt lds
    s_add_u32 m0, m0, 4096
    s_add_u32 s52, s52, 4096
    buffer_load_dwordx4 v5, s[40:43], s52 offen offset:0 nt lds
    buffer_load_dwordx4 v6, s[40:43], s52 offen offset:1024 nt lds
    buffer_load_dwordx4 v5, s[40:43], s52 offen offset:2048 nt lds
    buffer_load_dwordx4 v6, s[40:43], s52 offen offset:3072 nt lds
    s_add_u32 s52, s52, 4096
    s_and_b32 s52, s52, 0x3ffff
    s_sub_u32 s45, s45, 1
    s_cselect_b32 s42, 0, s42
    s_add_u32 s54, s54, 8192
    s_cmp_eq_u32 s54, s65
    s_cselect_b32 s54, 0, s54
    s_nop 4
    v_fma_f32 v144, v144, s48, -v20
    v_fma_f32 v145, v145, s48, -v20
    v_fma_f32 v146, v146, s48, -v20
    v_fma_f32 v147, v147, s48, -v20
    v_fma_f32 v148, v148, s48, -v21
    v_fma_f32 v149, v149, s48, -v21
    v_fma_f32 v150, v150, s48, -v21
    v_fma_f32 v151, v151, s48, -v21
    v_fma_f32 v152, v152, s48, -v22
    v_fma_f32 v153, v153, s48, -v22
    v_fma_f32 v154, v154, s48, -v22
    v_fma_f32 v155, v155, s48, -v22
    s_waitcnt vmcnt(40)
    ds_read_b128 v[208:211], v8 offset:0
    ds_read_b128 v[212:215], v9 offset:0
    ds_read_b128 v[216:219], v10 offset:0
    ds_read_b128 v[220:223], v11 offset:0
    ds_read_b128 v[224:227], v8 offset:4096
    ds_read_b128 v[228:231], v9 offset:4096
    ds_read_b128 v[232:235], v10 offset:4096
    ds_read_b128 v[236:239], v11 offset:4096
    v_max3_f32 v240, v132, v133, v134
    v_max3_f32 v240, v240, v135, v144
    v_max3_f32 v240, v240, v145, v146
    v_max_f32 v240, v240, v147
    v_max3_f32 v241, v136, v137, v138
    v_max3_f32 v241, v241, v139, v148
    v_max3_f32 v241, v241, v149, v150
    v_max_f32 v241, v241, v151
    v_max3_f32 v242, v140, v141, v142
    v_max3_f32 v242, v242, v143, v152
    v_max3_f32 v242, v242, v153, v154
    v_max_f32 v242, v242, v155
    v_mov_b32 v243, v240
    v_mov_b32 v244, v241
    v_mov_b32 v245, v242
    v_permlane32_swap_b32 v240, v243
    v_permlane32_swap_b32 v241, v244
    v_permlane32_swap_b32 v242, v245
    s_nop 1
    v_max_f32 v240, v240, v243
    v_max_f32 v241, v241, v244
    v_max_f32 v242, v242, v245
    v_mov_b32 v243, v240
    v_mov_b32 v244, v241
    v_mov_b32 v245, v242
    v_permlane16_swap_b32 v240, v243
    v_permlane16_swap_b32 v241, v244
    v_permlane16_swap_b32 v242, v245
    s_nop 1
    v_max_f32 v240, v240, v243
    v_max_f32 v241, v241, v244
    v_max_f32 v242, v242, v245
    v_add_f32 v20, v20, v240
    v_sub_f32 v132, v132, v240
    v_sub_f32 v133, v133, v240
    v_sub_f32 v134, v134, v240
    v_sub_f32 v135, v135, v240
    v_sub_f32 v144, v144, v240
    v_sub_f32 v145, v145, v240
    v_sub_f32 v146, v146, v240
    v_sub_f32 v147, v147, v240
    v_add_f32 v21, v21, v241
    v_sub_f32 v136, v136, v241
    v_sub_f32 v137, v137, v241
    v_sub_f32 v138, v138, v241
    v_sub_f32 v139, v139, v241
    v_sub_f32 v148, v148, v241
    v_sub_f32 v149, v149, v241
    v_sub_f32 v150, v150, v241
    v_sub_f32 v151, v151, v241
    v_add_f32 v22, v22, v242
    v_sub_f32 v140, v140, v242
    v_sub_f32 v141, v141, v242
    v_sub_f32 v142, v142, v242
    v_sub_f32 v143, v143, v242
    v_sub_f32 v152, v152, v242
    v_sub_f32 v153, v153, v242
    v_sub_f32 v154, v154, v242
    v_sub_f32 v155, v155, v242
    v_exp_f32 v132, v132
    v_exp_f32 v133, v133
    v_exp_f32 v134, v134
    v_exp_f32 v135, v135
    v_exp_f32 v136, v136
    v_exp_f32 v137, v137
    v_exp_f32 v138, v138
    v_exp_f32 v139, v139
    v_exp_f32 v140, v140
    v_exp_f32 v141, v141
    v_exp_f32 v142, v142
    v_exp_f32 v143, v143
    v_cvt_pk_bf16_f32 v240, v132, v133
    v_cvt_pk_bf16_f32 v241, v134, v135
    v_cvt_pk_bf16_f32 v244, v136, v137
    v_cvt_pk_bf16_f32 v245, v138, v139
    v_cvt_pk_bf16_f32 v248, v140, v141
    v_cvt_pk_bf16_f32 v249, v142, v143
L_loopB:
    s_waitcnt vmcnt(32)
    s_mov_b32 s59, s57
    s_add_u32 s57, s57, 8192
    s_cmp_eq_u32 s57, s64
    s_cselect_b32 s57, 0, s57
    s_sub_u32 s59, s57, s59
    s_waitcnt lgkmcnt(7)
    v_mfma_f32_16x16x32_bf16 v[132:135], v[208:211], v[156:159], 0
    v_exp_f32 v144, v144
    v_mfma_f32_16x16x32_bf16 v[136:139], v[208:211], v[172:175], 0
    v_exp_f32 v145, v145
    v_mfma_f32_16x16x32_bf16 v[140:143], v[208:211], v[188:191], 0
    v_exp_f32 v146, v146
    v_exp_f32 v147, v147
    ds_read_b64_tr_b16 v[208:209], v12 offset:0
    ds_read_b64_tr_b16 v[210:211], v12 offset:4096
    s_waitcnt lgkmcnt(8)
    v_mfma_f32_16x16x32_bf16 v[132:135], v[212:215], v[160:163], v[132:135]
    v_exp_f32 v148, v148
    v_mfma_f32_16x16x32_bf16 v[136:139], v[212:215], v[176:179], v[136:139]
    v_exp_f32 v149, v149
    v_mfma_f32_16x16x32_bf16 v[140:143], v[212:215], v[192:195], v[140:143]
    v_exp_f32 v150, v150
    v_exp_f32 v151, v151
    ds_read_b64_tr_b16 v[212:213], v13 offset:0
    ds_read_b64_tr_b16 v[214:215], v13 offset:4096
    s_waitcnt lgkmcnt(9)
    v_mfma_f32_16x16x32_bf16 v[132:135], v[216:219], v[164:167], v[132:135]
    v_exp_f32 v152, v152
    v_mfma_f32_16x16x32_bf16 v[136:139], v[216:219], v[180:183], v[136:139]
    v_exp_f32 v153, v153
    v_mfma_f32_16x16x32_bf16 v[140:143], v[216:219], v[196:199], v[140:143]
    v_exp_f32 v154, v154
    v_exp_f32 v155, v155
    ds_read_b64_tr_b16 v[216:217], v14 offset:0
    ds_read_b64_tr_b16 v[218:219], v14 offset:4096
    s_waitcnt lgkmcnt(6)
    v_mfma_f32_16x16x32_bf16 v[132:135], v[220:223], v[168:171], v[132:135]
    v_cvt_pk_bf16_f32 v242, v144, v145
    v_cvt_pk_bf16_f32 v243, v146, v147
    v_mfma_f32_16x16x32_bf16 v[136:139], v[220:223], v[184:187], v[136:139]
    v_cvt_pk_bf16_f32 v246, v148, v149
    v_cvt_pk_bf16_f32 v247, v150, v151
    v_mfma_f32_16x16x32_bf16 v[140:143], v[220:223], v[200:203], v[140:143]
    v_cvt_pk_bf16_f32 v250, v152, v153
    v_cvt_pk_bf16_f32 v251, v154, v155
    ds_read_b64_tr_b16 v[220:221], v15 offset:0
    ds_read_b64_tr_b16 v[222:223], v15 offset:4096
    s_cmp_eq_u32 s66, 0
    s_cbranch_scc1 L_th_16
    s_waitcnt vmcnt(6)
L_th_16:
    s_add_u32 m0, s53, s55
    s_nop 0
    buffer_load_dwordx4 v5, s[36:39], s51 offen offset:0 nt lds
    buffer_load_dwordx4 v6, s[36:39], s51 offen offset:1024 nt lds
    s_waitcnt lgkmcnt(13)
    v_mfma_f32_16x16x32_bf16 v[144:147], v[224:227], v[156:159], 0
    v_add_u32 v8, s59, v8
    v_mfma_f32_16x16x32_bf16 v[148:151], v[224:227], v[172:175], 0
    v_add_u32 v9, s59, v9
    v_mfma_f32_16x16x32_bf16 v[152:155], v[224:227], v[188:191], 0
    v_add_u32 v10, s59, v10
    v_add_u32 v11, s59, v11
    ds_read_b64_tr_b16 v[224:225], v16 offset:0
    ds_read_b64_tr_b16 v[226:227], v16 offset:4096
    buffer_load_dwordx4 v5, s[36:39], s51 offen offset:2048 nt lds
    buffer_load_dwordx4 v6, s[36:39], s51 offen offset:3072 nt lds
    s_waitcnt lgkmcnt(13)
    v_mfma_f32_16x16x32_bf16 v[144:147], v[228:231], v[160:163], v[144:147]
    v_fma_f32 v132, v132, s48, -v20
    v_fma_f32 v133, v133, s48, -v20
    v_mfma_f32_16x16x32_bf16 v[148:151], v[228:231], v[176:179], v[148:151]
    v_fma_f32 v134, v134, s48, -v20
    v_fma_f32 v135, v135, s48, -v20
    v_mfma_f32_16x16x32_bf16 v[152:155], v[228:231], v[192:195], v[152:155]
    v_fma_f32 v136, v136, s48, -v21
    v_max3_f32 v252, v132, v133, v134
    ds_read_b64_tr_b16 v[228:229], v17 offset:0
    ds_read_b64_tr_b16 v[230:231], v17 offset:4096
    s_add_u32 m0, m0, 4096
    s_add_u32 s51, s51, 4096
    buffer_load_dwordx4 v5, s[36:39], s51 offen offset:0 nt lds
    buffer_load_dwordx4 v6, s[36:39], s51 offen offset:1024 nt lds
    s_waitcnt lgkmcnt(13)
    v_mfma_f32_16x16x32_bf16 v[144:147], v[232:235], v[164:167], v[144:147]
    v_fma_f32 v137, v137, s48, -v21
    v_fma_f32 v138, v138, s48, -v21
    v_mfma_f32_16x16x32_bf16 v[148:151], v[232:235], v[180:183], v[148:151]
    v_max3_f32 v252, v252, v135, v136
    v_fma_f32 v139, v139, s48, -v21
    v_mfma_f32_16x16x32_bf16 v[152:155], v[232:235], v[196:199], v[152:155]
    v_fma_f32 v140, v140, s48, -v22
    v_max3_f32 v252, v252, v137, v138
    ds_read_b64_tr_b16 v[232:233], v18 offset:0
    ds_read_b64_tr_b16 v[234:235], v18 offset:4096
    buffer_load_dwordx4 v5, s[36:39], s51 offen offset:2048 nt lds
    buffer_load_dwordx4 v6, s[36:39], s51 offen offset:3072 nt lds
    s_waitcnt lgkmcnt(13)
    v_mfma_f32_16x16x32_bf16 v[144:147], v[236:239], v[168:171], v[144:147]
    v_fma_f32 v141, v141, s48, -v22
    v_fma_f32 v142, v142, s48, -v22
    v_mfma_f32_16x16x32_bf16 v[148:151], v[236:239], v[184:187], v[148:151]
    v_max3_f32 v252, v252, v139, v140
    v_fma_f32 v143, v143, s48, -v22
    v_mfma_f32_16x16x32_bf16 v[152:155], v[236:239], v[200:203], v[152:155]
    v_max3_f32 v252, v252, v141, v142
    v_max_f32 v252, v252, v143
    ds_read_b64_tr_b16 v[236:237], v19 offset:0
    ds_read_b64_tr_b16 v[238:239], v19 offset:4096
    s_add_u32 s51, s51, 4096
    s_and_b32 s51, s51, 0x3ffff
    s_sub_u32 s44, s44, 1
    s_cselect_b32 s38, 0, s38
    s_add_u32 s53, s53, 8192
    s_cmp_eq_u32 s53, s64
    s_cselect_b32 s53, 0, s53
    s_waitcnt lgkmcnt(14)
    s_mov_b32 s60, s58
    s_add_u32 s58, s58, 8192
    s_cmp_eq_u32 s58, s65
    s_cselect_b32 s58, 0, s58
    s_sub_u32 s60, s58, s60
    v_mfma_f32_16x16x32_bf16 v[24:27], v[208:211], v[240:243], v[24:27]
    v_add_u32 v12, s60, v12
    v_mfma_f32_16x16x32_bf16 v[28:31], v[208:211], v[244:247], v[28:31]
    v_add_u32 v13, s60, v13
    v_mfma_f32_16x16x32_bf16 v[32:35], v[208:211], v[248:251], v[32:35]
    v_add_u32 v14, s60, v14
    v_add_u32 v15, s60, v15
    s_waitcnt lgkmcnt(12)
    v_mfma_f32_16x16x32_bf16 v[36:39], v[212:215], v[240:243], v[36:39]
    v_fma_f32 v144, v144, s48, -v20
    v_fma_f32 v145, v145, s48, -v20
    v_mfma_f32_16x16x32_bf16 v[40:43], v[212:215], v[244:247], v[40:43]
    v_fma_f32 v146, v146, s48, -v20
    v_fma_f32 v147, v147, s48, -v20
    v_fma_f32 v148, v148, s48, -v21
    v_mfma_f32_16x16x32_bf16 v[44:47], v[212:215], v[248:251], v[44:47]
    v_max3_f32 v253, v144, v145, v146
    v_fma_f32 v149, v149, s48, -v21
    v_fma_f32 v150, v150, s48, -v21
    ds_read_b32 v3, v2 offset:96
    s_waitcnt lgkmcnt(0)
    v_readfirstlane_b32 s66, v3
    v_mfma_f32_16x16x32_bf16 v[48:51], v[216:219], v[240:243], v[48:51]
    v_max3_f32 v253, v253, v147, v148
    v_fma_f32 v151, v151, s48, -v21
    v_fma_f32 v152, v152, s48, -v22
    v_mfma_f32_16x16x32_bf16 v[52:55], v[216:219], v[244:247], v[52:55]
    v_max3_f32 v253, v253, v149, v150
    v_fma_f32 v153, v153, s48, -v22
    v_fma_f32 v154, v154, s48, -v22
    v_mfma_f32_16x16x32_bf16 v[56:59], v[216:219], v[248:251], v[56:59]
    v_max3_f32 v253, v253, v151, v152
    v_fma_f32 v155, v155, s48, -v22
    v_max3_f32 v253, v253, v153, v154
    v_max3_f32 v253, v253, v155, v252
    v_cmp_nge_f32 vcc, s49, v253
    s_cbranch_vccnz L_rare_B1
    s_cmp_eq_u32 s66, 0
    s_cbranch_scc1 L_th_17
    s_waitcnt vmcnt(6)
L_th_17:
    s_add_u32 m0, s54, s56
    s_nop 0
    buffer_load_dwordx4 v5, s[40:43], s52 offen offset:0 nt lds
    buffer_load_dwordx4 v6, s[40:43], s52 offen offset:1024 nt lds
    buffer_load_dwordx4 v5, s[40:43], s52 offen offset:2048 nt lds
    buffer_load_dwordx4 v6, s[40:43], s52 offen offset:3072 nt lds
    v_mfma_f32_16x16x32_bf16 v[60:63], v[220:223], v[240:243], v[60:63]
    v_exp_f32 v132, v132
    v_exp_f32 v133, v133
    v_mfma_f32_16x16x32_bf16 v[64:67], v[220:223], v[244:247], v[64:67]
    v_add_u32 v16, s60, v16
    v_add_u32 v17, s60, v17
    v_mfma_f32_16x16x32_bf16 v[68:71], v[220:223], v[248:251], v[68:71]
    v_add_u32 v18, s60, v18
    v_add_u32 v19, s60, v19
    s_add_u32 m0, m0, 4096
    s_add_u32 s52, s52, 4096
    buffer_load_dwordx4 v5, s[40:43], s52 offen offset:0 nt lds
    buffer_load_dwordx4 v6, s[40:43], s52 offen offset:1024 nt lds
    buffer_load_dwordx4 v5, s[40:43], s52 offen offset:2048 nt lds
    buffer_load_dwordx4 v6, s[40:43], s52 offen offset:3072 nt lds
    s_add_u32 s52, s52, 4096
    s_and_b32 s52, s52, 0x3ffff
    s_sub_u32 s45, s45, 1
    s_cselect_b32 s42, 0, s42
    s_add_u32 s54, s54, 8192
    s_cmp_eq_u32 s54, s65
    s_cselect_b32 s54, 0, s54
    s_waitcnt vmcnt(40)
    ds_read_b128 v[208:211], v8 offset:0
    ds_read_b128 v[212:215], v9 offset:0
    ds_read_b128 v[216:219], v10 offset:0
    ds_read_b128 v[220:223], v11 offset:0
    v_mfma_f32_16x16x32_bf16 v[72:75], v[224:227], v[240:243], v[72:75]
    v_mfma_f32_16x16x32_bf16 v[76:79], v[224:227], v[244:247], v[76:79]
    v_exp_f32 v134, v134
    v_mfma_f32_16x16x32_bf16 v[80:83], v[224:227], v[248:251], v[80:83]
    v_exp_f32 v135, v135
    ds_read_b128 v[224:227], v8 offset:4096
    v_mfma_f32_16x16x32_bf16 v[84:87], v[228:231], v[240:243], v[84:87]
    v_mfma_f32_16x16x32_bf16 v[88:91], v[228:231], v[244:247], v[88:91]
    v_exp_f32 v136, v136
    v_mfma_f32_16x16x32_bf16 v[92:95], v[228:231], v[248:251], v[92:95]
    v_exp_f32 v137, v137
    ds_read_b128 v[228:231], v9 offset:4096
    v_mfma_f32_16x16x32_bf16 v[96:99], v[232:235], v[240:243], v[96:99]
    v_mfma_f32_16x16x32_bf16 v[100:103], v[232:235], v[244:247], v[100:103]
    v_exp_f32 v138, v138
    v_mfma_f32_16x16x32_bf16 v[104:107], v[232:235], v[248:251], v[104:107]
    v_exp_f32 v139, v139
    ds_read_b128 v[232:235], v10 offset:4096
    v_mfma_f32_16x16x32_bf16 v[108:111], v[236:239], v[240:243], v[108:111]
    v_mfma_f32_16x16x32_bf16 v[112:115], v[236:239], v[244:247], v[112:115]
    v_exp_f32 v140, v140
    v_mfma_f32_16x16x32_bf16 v[116:119], v[236:239], v[248:251], v[116:119]
    v_exp_f32 v141, v141
    ds_read_b128 v[236:239], v11 offset:4096
    v_mfma_f32_16x16x32_bf16 v[120:123], v[204:207], v[240:243], v[120:123]
    v_mfma_f32_16x16x32_bf16 v[124:127], v[204:207], v[244:247], v[124:127]
    v_exp_f32 v142, v142
    v_mfma_f32_16x16x32_bf16 v[128:131], v[204:207], v[248:251], v[128:131]
    v_exp_f32 v143, v143
L_join_B1:
    s_nop 0
    v_cvt_pk_bf16_f32 v240, v132, v133
    v_cvt_pk_bf16_f32 v241, v134, v135
    v_cvt_pk_bf16_f32 v244, v136, v137
    v_cvt_pk_bf16_f32 v245, v138, v139
    v_cvt_pk_bf16_f32 v248, v140, v141
    v_cvt_pk_bf16_f32 v249, v142, v143
    s_add_u32 s50, s50, 1
    s_cmp_lt_u32 s50, 31
    s_cbranch_scc1 L_loopB
    s_waitcnt vmcnt(32)
    s_mov_b32 s59, s57
    s_add_u32 s57, s57, 8192
    s_cmp_eq_u32 s57, s64
    s_cselect_b32 s57, 0, s57
    s_sub_u32 s59, s57, s59
    s_waitcnt lgkmcnt(7)
    v_mfma_f32_16x16x32_bf16 v[132:135], v[208:211], v[156:159], 0
    v_exp_f32 v144, v144
    v_mfma_f32_16x16x32_bf16 v[136:139], v[208:211], v[172:175], 0
    v_exp_f32 v145, v145
    v_mfma_f32_16x16x32_bf16 v[140:143], v[208:211], v[188:191], 0
    v_exp_f32 v146, v146
    v_exp_f32 v147, v147
    ds_read_b64_tr_b16 v[208:209], v12 offset:0
    ds_read_b64_tr_b16 v[210:211], v12 offset:4096
    s_waitcnt lgkmcnt(8)
    v_mfma_f32_16x16x32_bf16 v[132:135], v[212:215], v[160:163], v[132:135]
    v_exp_f32 v148, v148
    v_mfma_f32_16x16x32_bf16 v[136:139], v[212:215], v[176:179], v[136:139]
    v_exp_f32 v149, v149
    v_mfma_f32_16x16x32_bf16 v[140:143], v[212:215], v[192:195], v[140:143]
    v_exp_f32 v150, v150
    v_exp_f32 v151, v151
    ds_read_b64_tr_b16 v[212:213], v13 offset:0
    ds_read_b64_tr_b16 v[214:215], v13 offset:4096
    s_waitcnt lgkmcnt(9)
    v_mfma_f32_16x16x32_bf16 v[132:135], v[216:219], v[164:167], v[132:135]
    v_exp_f32 v152, v152
    v_mfma_f32_16x16x32_bf16 v[136:139], v[216:219], v[180:183], v[136:139]
    v_exp_f32 v153, v153
    v_mfma_f32_16x16x32_bf16 v[140:143], v[216:219], v[196:199], v[140:143]
    v_exp_f32 v154, v154
    v_exp_f32 v155, v155
    ds_read_b64_tr_b16 v[216:217], v14 offset:0
    ds_read_b64_tr_b16 v[218:219], v14 offset:4096
    s_waitcnt lgkmcnt(6)
    v_mfma_f32_16x16x32_bf16 v[132:135], v[220:223], v[168:171], v[132:135]
    v_cvt_pk_bf16_f32 v242, v144, v145
    v_cvt_pk_bf16_f32 v243, v146, v147
    v_mfma_f32_16x16x32_bf16 v[136:139], v[220:223], v[184:187], v[136:139]
    v_cvt_pk_bf16_f32 v246, v148, v149
    v_cvt_pk_bf16_f32 v247, v150, v151
    v_mfma_f32_16x16x32_bf16 v[140:143], v[220:223], v[200:203], v[140:143]
    v_cvt_pk_bf16_f32 v250, v152, v153
    v_cvt_pk_bf16_f32 v251, v154, v155
    ds_read_b64_tr_b16 v[220:221], v15 offset:0
    ds_read_b64_tr_b16 v[222:223], v15 offset:4096
    s_cmp_eq_u32 s66, 0
    s_cbranch_scc1 L_th_18
    s_waitcnt vmcnt(6)
L_th_18:
    s_add_u32 m0, s53, s55
    s_nop 0
    buffer_load_dwordx4 v5, s[36:39], s51 offen offset:0 nt lds
    buffer_load_dwordx4 v6, s[36:39], s51 offen offset:1024 nt lds
    s_waitcnt lgkmcnt(13)
    v_mfma_f32_16x16x32_bf16 v[144:147], v[224:227], v[156:159], 0
    v_add_u32 v8, s59, v8
    v_mfma_f32_16x16x32_bf16 v[148:151], v[224:227], v[172:175], 0
    v_add_u32 v9, s59, v9
    v_mfma_f32_16x16x32_bf16 v[152:155], v[224:227], v[188:191], 0
    v_add_u32 v10, s59, v10
    v_add_u32 v11, s59, v11
    ds_read_b64_tr_b16 v[224:225], v16 offset:0
    ds_read_b64_tr_b16 v[226:227], v16 offset:4096
    buffer_load_dwordx4 v5, s[36:39], s51 offen offset:2048 nt lds
    buffer_load_dwordx4 v6, s[36:39], s51 offen offset:3072 nt lds
    s_waitcnt lgkmcnt(13)
    v_mfma_f32_16x16x32_bf16 v[144:147], v[228:231], v[160:163], v[144:147]
    v_fma_f32 v132, v132, s48, -v20
    v_fma_f32 v133, v133, s48, -v20
    v_mfma_f32_16x16x32_bf16 v[148:151], v[228:231], v[176:179], v[148:151]
    v_fma_f32 v134, v134, s48, -v20
    v_fma_f32 v135, v135, s48, -v20
    v_mfma_f32_16x16x32_bf16 v[152:155], v[228:231], v[192:195], v[152:155]
    v_fma_f32 v136, v136, s48, -v21
    v_max3_f32 v252, v132, v133, v134
    ds_read_b64_tr_b16 v[228:229], v17 offset:0
    ds_read_b64_tr_b16 v[230:231], v17 offset:4096
    s_add_u32 m0, m0, 4096
    s_add_u32 s51, s51, 4096
    buffer_load_dwordx4 v5, s[36:39], s51 offen offset:0 nt lds
    buffer_load_dwordx4 v6, s[36:39], s51 offen offset:1024 nt lds
    s_waitcnt lgkmcnt(13)
    v_mfma_f32_16x16x32_bf16 v[144:147], v[232:235], v[164:167], v[144:147]
    v_fma_f32 v137, v137, s48, -v21
    v_fma_f32 v138, v138, s48, -v21
    v_mfma_f32_16x16x32_bf16 v[148:151], v[232:235], v[180:183], v[148:151]
    v_max3_f32 v252, v252, v135, v136
    v_fma_f32 v139, v139, s48, -v21
    v_mfma_f32_16x16x32_bf16 v[152:155], v[232:235], v[196:199], v[152:155]
    v_fma_f32 v140, v140, s48, -v22
    v_max3_f32 v252, v252, v137, v138
    ds_read_b64_tr_b16 v[232:233], v18 offset:0
    ds_read_b64_tr_b16 v[234:235], v18 offset:4096
    buffer_load_dwordx4 v5, s[36:39], s51 offen offset:2048 nt lds
    buffer_load_dwordx4 v6, s[36:39], s51 offen offset:3072 nt lds
    s_waitcnt lgkmcnt(13)
    v_mfma_f32_16x16x32_bf16 v[144:147], v[236:239], v[168:171], v[144:147]
    v_fma_f32 v141, v141, s48, -v22
    v_fma_f32 v142, v142, s48, -v22
    v_mfma_f32_16x16x32_bf16 v[148:151], v[236:239], v[184:187], v[148:151]
    v_max3_f32 v252, v252, v139, v140
    v_fma_f32 v143, v143, s48, -v22
    v_mfma_f32_16x16x32_bf16 v[152:155], v[236:239], v[200:203], v[152:155]
    v_max3_f32 v252, v252, v141, v142
    v_max_f32 v252, v252, v143
    ds_read_b64_tr_b16 v[236:237], v19 offset:0
    ds_read_b64_tr_b16 v[238:239], v19 offset:4096
    s_add_u32 s51, s51, 4096
    s_and_b32 s51, s51, 0x3ffff
    s_sub_u32 s44, s44, 1
    s_cselect_b32 s38, 0, s38
    s_add_u32 s53, s53, 8192
    s_cmp_eq_u32 s53, s64
    s_cselect_b32 s53, 0, s53
    s_waitcnt lgkmcnt(14)
    s_mov_b32 s60, s58
    s_add_u32 s58, s58, 8192
    s_cmp_eq_u32 s58, s65
    s_cselect_b32 s58, 0, s58
    s_sub_u32 s60, s58, s60
    v_mfma_f32_16x16x32_bf16 v[24:27], v[208:211], v[240:243], v[24:27]
    v_add_u32 v12, s60, v12
    v_mfma_f32_16x16x32_bf16 v[28:31], v[208:211], v[244:247], v[28:31]
    v_add_u32 v13, s60, v13
    v_mfma_f32_16x16x32_bf16 v[32:35], v[208:211], v[248:251], v[32:35]
    v_add_u32 v14, s60, v14
    v_add_u32 v15, s60, v15
    s_waitcnt lgkmcnt(12)
    v_mfma_f32_16x16x32_bf16 v[36:39], v[212:215], v[240:243], v[36:39]
    v_fma_f32 v144, v144, s48, -v20
    v_fma_f32 v145, v145, s48, -v20
    v_mfma_f32_16x16x32_bf16 v[40:43], v[212:215], v[244:247], v[40:43]
    v_fma_f32 v146, v146, s48, -v20
    v_fma_f32 v147, v147, s48, -v20
    v_fma_f32 v148, v148, s48, -v21
    v_mfma_f32_16x16x32_bf16 v[44:47], v[212:215], v[248:251], v[44:47]
    v_max3_f32 v253, v144, v145, v146
    v_fma_f32 v149, v149, s48, -v21
    v_fma_f32 v150, v150, s48, -v21
    ds_read_b32 v3, v2 offset:96
    s_waitcnt lgkmcnt(0)
    v_readfirstlane_b32 s66, v3
    v_mfma_f32_16x16x32_bf16 v[48:51], v[216:219], v[240:243], v[48:51]
    v_max3_f32 v253, v253, v147, v148
    v_fma_f32 v151, v151, s48, -v21
    v_fma_f32 v152, v152, s48, -v22
    v_mfma_f32_16x16x32_bf16 v[52:55], v[216:219], v[244:247], v[52:55]
    v_max3_f32 v253, v253, v149, v150
    v_fma_f32 v153, v153, s48, -v22
    v_fma_f32 v154, v154, s48, -v22
    v_mfma_f32_16x16x32_bf16 v[56:59], v[216:219], v[248:251], v[56:59]
    v_max3_f32 v253, v253, v151, v152
    v_fma_f32 v155, v155, s48, -v22
    v_max3_f32 v253, v253, v153, v154
    v_max3_f32 v253, v253, v155, v252
    v_cmp_nge_f32 vcc, s49, v253
    s_cbranch_vccnz L_rare_B2
    s_cmp_eq_u32 s66, 0
    s_cbranch_scc1 L_th_19
    s_waitcnt vmcnt(6)
L_th_19:
    s_add_u32 m0, s54, s56
    s_nop 0
    buffer_load_dwordx4 v5, s[40:43], s52 offen offset:0 nt lds
    buffer_load_dwordx4 v6, s[40:43], s52 offen offset:1024 nt lds
    buffer_load_dwordx4 v5, s[40:43], s52 offen offset:2048 nt lds
    buffer_load_dwordx4 v6, s[40:43], s52 offen offset:3072 nt lds
    v_mfma_f32_16x16x32_bf16 v[60:63], v[220:223], v[240:243], v[60:63]
    v_exp_f32 v132, v132
    v_exp_f32 v133, v133
    v_mfma_f32_16x16x32_bf16 v[64:67], v[220:223], v[244:247], v[64:67]
    v_add_u32 v16, s60, v16
    v_add_u32 v17, s60, v17
    v_mfma_f32_16x16x32_bf16 v[68:71], v[220:223], v[248:251], v[68:71]
    v_add_u32 v18, s60, v18
    v_add_u32 v19, s60, v19
    s_add_u32 m0, m0, 4096
    s_add_u32 s52, s52, 4096
    buffer_load_dwordx4 v5, s[40:43], s52 offen offset:0 nt lds
    buffer_load_dwordx4 v6, s[40:43], s52 offen offset:1024 nt lds
    buffer_load_dwordx4 v5, s[40:43], s52 offen offset:2048 nt lds
    buffer_load_dwordx4 v6, s[40:43], s52 offen offset:3072 nt lds
    s_add_u32 s52, s52, 4096
    s_and_b32 s52, s52, 0x3ffff
    s_sub_u32 s45, s45, 1
    s_cselect_b32 s42, 0, s42
    s_add_u32 s54, s54, 8192
    s_cmp_eq_u32 s54, s65
    s_cselect_b32 s54, 0, s54
    s_waitcnt vmcnt(40)
    v_mfma_f32_16x16x32_bf16 v[72:75], v[224:227], v[240:243], v[72:75]
    v_mfma_f32_16x16x32_bf16 v[76:79], v[224:227], v[244:247], v[76:79]
    v_exp_f32 v134, v134
    v_mfma_f32_16x16x32_bf16 v[80:83], v[224:227], v[248:251], v[80:83]
    v_exp_f32 v135, v135
    v_mfma_f32_16x16x32_bf16 v[84:87], v[228:231], v[240:243], v[84:87]
    v_mfma_f32_16x16x32_bf16 v[88:91], v[228:231], v[244:247], v[88:91]
    v_exp_f32 v136, v136
    v_mfma_f32_16x16x32_bf16 v[92:95], v[228:231], v[248:251], v[92:95]
    v_exp_f32 v137, v137
    v_mfma_f32_16x16x32_bf16 v[96:99], v[232:235], v[240:243], v[96:99]
    v_mfma_f32_16x16x32_bf16 v[100:103], v[232:235], v[244:247], v[100:103]
    v_exp_f32 v138, v138
    v_mfma_f32_16x16x32_bf16 v[104:107], v[232:235], v[248:251], v[104:107]
    v_exp_f32 v139, v139
    v_mfma_f32_16x16x32_bf16 v[108:111], v[236:239], v[240:243], v[108:111]
    v_mfma_f32_16x16x32_bf16 v[112:115], v[236:239], v[244:247], v[112:115]
    v_exp_f32 v140, v140
    v_mfma_f32_16x16x32_bf16 v[116:119], v[236:239], v[248:251], v[116:119]
    v_exp_f32 v141, v141
    v_mfma_f32_16x16x32_bf16 v[120:123], v[204:207], v[240:243], v[120:123]
    v_mfma_f32_16x16x32_bf16 v[124:127], v[204:207], v[244:247], v[124:127]
    v_exp_f32 v142, v142
    v_mfma_f32_16x16x32_bf16 v[128:131], v[204:207], v[248:251], v[128:131]
    v_exp_f32 v143, v143
L_join_B2:
    s_nop 0
    v_cvt_pk_bf16_f32 v240, v132, v133
    v_cvt_pk_bf16_f32 v241, v134, v135
    v_cvt_pk_bf16_f32 v244, v136, v137
    v_cvt_pk_bf16_f32 v245, v138, v139
    v_cvt_pk_bf16_f32 v248, v140, v141
    v_cvt_pk_bf16_f32 v249, v142, v143
    s_waitcnt vmcnt(32)
    ds_read_b64_tr_b16 v[208:209], v12 offset:0
    ds_read_b64_tr_b16 v[210:211], v12 offset:4096
    ds_read_b64_tr_b16 v[212:213], v13 offset:0
    ds_read_b64_tr_b16 v[214:215], v13 offset:4096
    ds_read_b64_tr_b16 v[216:217], v14 offset:0
    ds_read_b64_tr_b16 v[218:219], v14 offset:4096
    ds_read_b64_tr_b16 v[220:221], v15 offset:0
    ds_read_b64_tr_b16 v[222:223], v15 offset:4096
    ds_read_b64_tr_b16 v[224:225], v16 offset:0
    ds_read_b64_tr_b16 v[226:227], v16 offset:4096
    ds_read_b64_tr_b16 v[228:229], v17 offset:0
    ds_read_b64_tr_b16 v[230:231], v17 offset:4096
    ds_read_b64_tr_b16 v[232:233], v18 offset:0
    ds_read_b64_tr_b16 v[234:235], v18 offset:4096
    v_exp_f32 v144, v144
    v_exp_f32 v145, v145
    v_exp_f32 v146, v146
    v_exp_f32 v147, v147
    v_exp_f32 v148, v148
    v_exp_f32 v149, v149
    v_exp_f32 v150, v150
    v_exp_f32 v151, v151
    v_exp_f32 v152, v152
    v_exp_f32 v153, v153
    v_exp_f32 v154, v154
    v_exp_f32 v155, v155
    s_waitcnt lgkmcnt(6)
    ds_read_b64_tr_b16 v[236:237], v19 offset:0
    ds_read_b64_tr_b16 v[238:239], v19 offset:4096
    v_cvt_pk_bf16_f32 v242, v144, v145
    v_cvt_pk_bf16_f32 v243, v146, v147
    v_cvt_pk_bf16_f32 v246, v148, v149
    v_cvt_pk_bf16_f32 v247, v150, v151
    v_cvt_pk_bf16_f32 v250, v152, v153
    v_cvt_pk_bf16_f32 v251, v154, v155
    s_waitcnt lgkmcnt(0)
    v_mfma_f32_16x16x32_bf16 v[24:27], v[208:211], v[240:243], v[24:27]
    v_mfma_f32_16x16x32_bf16 v[28:31], v[208:211], v[244:247], v[28:31]
    v_mfma_f32_16x16x32_bf16 v[32:35], v[208:211], v[248:251], v[32:35]
    v_mfma_f32_16x16x32_bf16 v[36:39], v[212:215], v[240:243], v[36:39]
    v_mfma_f32_16x16x32_bf16 v[40:43], v[212:215], v[244:247], v[40:43]
    v_mfma_f32_16x16x32_bf16 v[44:47], v[212:215], v[248:251], v[44:47]
    v_mfma_f32_16x16x32_bf16 v[48:51], v[216:219], v[240:243], v[48:51]
    v_mfma_f32_16x16x32_bf16 v[52:55], v[216:219], v[244:247], v[52:55]
    v_mfma_f32_16x16x32_bf16 v[56:59], v[216:219], v[248:251], v[56:59]
    v_mfma_f32_16x16x32_bf16 v[60:63], v[220:223], v[240:243], v[60:63]
    v_mfma_f32_16x16x32_bf16 v[64:67], v[220:223], v[244:247], v[64:67]
    v_mfma_f32_16x16x32_bf16 v[68:71], v[220:223], v[248:251], v[68:71]
    v_mfma_f32_16x16x32_bf16 v[72:75], v[224:227], v[240:243], v[72:75]
    v_mfma_f32_16x16x32_bf16 v[76:79], v[224:227], v[244:247], v[76:79]
    v_mfma_f32_16x16x32_bf16 v[80:83], v[224:227], v[248:251], v[80:83]
    v_mfma_f32_16x16x32_bf16 v[84:87], v[228:231], v[240:243], v[84:87]
    v_mfma_f32_16x16x32_bf16 v[88:91], v[228:231], v[244:247], v[88:91]
    v_mfma_f32_16x16x32_bf16 v[92:95], v[228:231], v[248:251], v[92:95]
    v_mfma_f32_16x16x32_bf16 v[96:99], v[232:235], v[240:243], v[96:99]
    v_mfma_f32_16x16x32_bf16 v[100:103], v[232:235], v[244:247], v[100:103]
    v_mfma_f32_16x16x32_bf16 v[104:107], v[232:235], v[248:251], v[104:107]
    v_mfma_f32_16x16x32_bf16 v[108:111], v[236:239], v[240:243], v[108:111]
    v_mfma_f32_16x16x32_bf16 v[112:115], v[236:239], v[244:247], v[112:115]
    v_mfma_f32_16x16x32_bf16 v[116:119], v[236:239], v[248:251], v[116:119]
    v_mfma_f32_16x16x32_bf16 v[120:123], v[204:207], v[240:243], v[120:123]
    v_mfma_f32_16x16x32_bf16 v[124:127], v[204:207], v[244:247], v[124:127]
    v_mfma_f32_16x16x32_bf16 v[128:131], v[204:207], v[248:251], v[128:131]
    s_branch L_out
L_runA:
L_p_20:
    ds_read_b32 v3, v2 offset:4
    s_waitcnt lgkmcnt(0)
    v_readfirstlane_b32 s31, v3
    s_cmp_ge_u32 s31, 4
    s_cbranch_scc1 L_q_21
    s_sleep 2
    s_branch L_p_20
L_q_21:
    ds_write_b32 v2, v4 offset:96
    v_add_u32 v7, s55, v1
    s_waitcnt vmcnt(0)
    ds_write_b128 v7, v[28:31] offset:0
    ds_write_b128 v7, v[32:35] offset:1024
    ds_write_b128 v7, v[36:39] offset:2048
    ds_write_b128 v7, v[40:43] offset:3072
    ds_write_b128 v7, v[44:47] offset:4096
    ds_write_b128 v7, v[48:51] offset:5120
    ds_write_b128 v7, v[52:55] offset:6144
    ds_write_b128 v7, v[56:59] offset:7168
    s_waitcnt lgkmcnt(4)
    ds_write_b128 v7, v[60:63] offset:8192
    ds_write_b128 v7, v[64:67] offset:9216
    ds_write_b128 v7, v[68:71] offset:10240
    ds_write_b128 v7, v[72:75] offset:11264
    ds_write_b128 v7, v[76:79] offset:12288
    ds_write_b128 v7, v[80:83] offset:13312
    ds_write_b128 v7, v[84:87] offset:14336
    ds_write_b128 v7, v[88:91] offset:15360
    s_waitcnt lgkmcnt(4)
    ds_write_b128 v7, v[92:95] offset:16384
    ds_write_b128 v7, v[96:99] offset:17408
    ds_write_b128 v7, v[100:103] offset:18432
    ds_write_b128 v7, v[104:107] offset:19456
    ds_write_b128 v7, v[108:111] offset:20480
    ds_write_b128 v7, v[112:115] offset:21504
    ds_write_b128 v7, v[116:119] offset:22528
    ds_write_b128 v7, v[120:123] offset:23552
    s_waitcnt lgkmcnt(4)
    s_waitcnt lgkmcnt(0)
    v_mov_b32 v24, 0
    v_mov_b32 v25, 0
    v_mov_b32 v26, 0
    v_mov_b32 v27, 0
    v_mov_b32 v28, 0
    v_mov_b32 v29, 0
    v_mov_b32 v30, 0
    v_mov_b32 v31, 0
    v_mov_b32 v32, 0
    v_mov_b32 v33, 0
    v_mov_b32 v34, 0
    v_mov_b32 v35, 0
    v_mov_b32 v36, 0
    v_mov_b32 v37, 0
    v_mov_b32 v38, 0
    v_mov_b32 v39, 0
    v_mov_b32 v40, 0
    v_mov_b32 v41, 0
    v_mov_b32 v42, 0
    v_mov_b32 v43, 0
    v_mov_b32 v44, 0
    v_mov_b32 v45, 0
    v_mov_b32 v46, 0
    v_mov_b32 v47, 0
    v_mov_b32 v48, 0
    v_mov_b32 v49, 0
    v_mov_b32 v50, 0
    v_mov_b32 v51, 0
    v_mov_b32 v52, 0
    v_mov_b32 v53, 0
    v_mov_b32 v54, 0
    v_mov_b32 v55, 0
    v_mov_b32 v56, 0
    v_mov_b32 v57, 0
    v_mov_b32 v58, 0
    v_mov_b32 v59, 0
    v_mov_b32 v60, 0
    v_mov_b32 v61, 0
    v_mov_b32 v62, 0
    v_mov_b32 v63, 0
    v_mov_b32 v64, 0
    v_mov_b32 v65, 0
    v_mov_b32 v66, 0
    v_mov_b32 v67, 0
    v_mov_b32 v68, 0
    v_mov_b32 v69, 0
    v_mov_b32 v70, 0
    v_mov_b32 v71, 0
    v_mov_b32 v72, 0
    v_mov_b32 v73, 0
    v_mov_b32 v74, 0
    v_mov_b32 v75, 0
    v_mov_b32 v76, 0
    v_mov_b32 v77, 0
    v_mov_b32 v78, 0
    v_mov_b32 v79, 0
    v_mov_b32 v80, 0
    v_mov_b32 v81, 0
    v_mov_b32 v82, 0
    v_mov_b32 v83, 0
    v_mov_b32 v84, 0
    v_mov_b32 v85, 0
    v_mov_b32 v86, 0
    v_mov_b32 v87, 0
    v_mov_b32 v88, 0
    v_mov_b32 v89, 0
    v_mov_b32 v90, 0
    v_mov_b32 v91, 0
    v_mov_b32 v92, 0
    v_mov_b32 v93, 0
    v_mov_b32 v94, 0
    v_mov_b32 v95, 0
    v_mov_b32 v96, 0
    v_mov_b32 v97, 0
    v_mov_b32 v98, 0
    v_mov_b32 v99, 0
    v_mov_b32 v100, 0
    v_mov_b32 v101, 0
    v_mov_b32 v102, 0
    v_mov_b32 v103, 0
    v_mov_b32 v104, 0
    v_mov_b32 v105, 0
    v_mov_b32 v106, 0
    v_mov_b32 v107, 0
    v_mov_b32 v108, 0
    v_mov_b32 v109, 0
    v_mov_b32 v110, 0
    v_mov_b32 v111, 0
    v_mov_b32 v112, 0
    v_mov_b32 v113, 0
    v_mov_b32 v114, 0
    v_mov_b32 v115, 0
    v_mov_b32 v116, 0
    v_mov_b32 v117, 0
    v_mov_b32 v118, 0
    v_mov_b32 v119, 0
    v_mov_b32 v120, 0
    v_mov_b32 v121, 0
    v_mov_b32 v122, 0
    v_mov_b32 v123, 0
    v_mov_b32 v124, 0
    v_mov_b32 v125, 0
    v_mov_b32 v126, 0
    v_mov_b32 v127, 0
    v_mov_b32 v128, 0
    v_mov_b32 v129, 0
    v_mov_b32 v130, 0
    v_mov_b32 v131, 0
    s_waitcnt lgkmcnt(0)
    s_mov_b64 exec, 1
    ds_add_u32 v2, v4 offset:12
    s_mov_b64 exec, -1
    s_add_u32 s61, s61, 2
L_p_22:
    ds_read_b32 v3, v2 offset:12
    s_waitcnt lgkmcnt(0)
    v_readfirstlane_b32 s31, v3
    s_cmp_ge_u32 s31, s61
    s_cbranch_scc1 L_q_23
    s_branch L_p_22
L_q_23:
    ds_read_b128 v[208:211], v8 offset:0
    ds_read_b128 v[212:215], v9 offset:0
    ds_read_b128 v[216:219], v10 offset:0
    ds_read_b128 v[220:223], v11 offset:0
    ds_read_b128 v[224:227], v8 offset:4096
    ds_read_b128 v[228:231], v9 offset:4096
    ds_read_b128 v[232:235], v10 offset:4096
    ds_read_b128 v[236:239], v11 offset:4096
    s_mov_b32 s59, s57
    s_add_u32 s57, s57, 8192
    s_cmp_eq_u32 s57, s64
    s_cselect_b32 s57, 0, s57
    s_sub_u32 s59, s57, s59
    s_waitcnt lgkmcnt(7)
    v_mfma_f32_16x16x32_bf16 v[132:135], v[208:211], v[156:159], 0
    v_mfma_f32_16x16x32_bf16 v[136:139], v[208:211], v[172:175], 0
    v_mfma_f32_16x16x32_bf16 v[140:143], v[208:211], v[188:191], 0
    s_waitcnt lgkmcnt(6)
    v_mfma_f32_16x16x32_bf16 v[132:135], v[212:215], v[160:163], v[132:135]
    v_mfma_f32_16x16x32_bf16 v[136:139], v[212:215], v[176:179], v[136:139]
    v_mfma_f32_16x16x32_bf16 v[140:143], v[212:215], v[192:195], v[140:143]
    s_waitcnt lgkmcnt(5)
    v_mfma_f32_16x16x32_bf16 v[132:135], v[216:219], v[164:167], v[132:135]
    v_mfma_f32_16x16x32_bf16 v[136:139], v[216:219], v[180:183], v[136:139]
    v_mfma_f32_16x16x32_bf16 v[140:143], v[216:219], v[196:199], v[140:143]
    s_waitcnt lgkmcnt(4)
    v_mfma_f32_16x16x32_bf16 v[132:135], v[220:223], v[168:171], v[132:135]
    v_mfma_f32_16x16x32_bf16 v[136:139], v[220:223], v[184:187], v[136:139]
    v_mfma_f32_16x16x32_bf16 v[140:143], v[220:223], v[200:203], v[140:143]
    s_waitcnt lgkmcnt(0)
    s_waitcnt lgkmcnt(3)
    v_mfma_f32_16x16x32_bf16 v[144:147], v[224:227], v[156:159], 0
    v_add_u32 v8, s59, v8
    v_mfma_f32_16x16x32_bf16 v[148:151], v[224:227], v[172:175], 0
    v_add_u32 v9, s59, v9
    v_mfma_f32_16x16x32_bf16 v[152:155], v[224:227], v[188:191], 0
    v_add_u32 v10, s59, v10
    v_add_u32 v11, s59, v11
    s_waitcnt lgkmcnt(2)
    v_mfma_f32_16x16x32_bf16 v[144:147], v[228:231], v[160:163], v[144:147]
    v_fma_f32 v132, v132, s48, -v20
    v_fma_f32 v133, v133, s48, -v20
    v_mfma_f32_16x16x32_bf16 v[148:151], v[228:231], v[176:179], v[148:151]
    v_fma_f32 v134, v134, s48, -v20
    v_fma_f32 v135, v135, s48, -v20
    v_mfma_f32_16x16x32_bf16 v[152:155], v[228:231], v[192:195], v[152:155]
    v_fma_f32 v136, v136, s48, -v21
    v_max3_f32 v252, v132, v133, v134
    s_waitcnt lgkmcnt(1)
    v_mfma_f32_16x16x32_bf16 v[144:147], v[232:235], v[164:167], v[144:147]
    v_fma_f32 v137, v137, s48, -v21
    v_fma_f32 v138, v138, s48, -v21
    v_mfma_f32_16x16x32_bf16 v[148:151], v[232:235], v[180:183], v[148:151]
    v_max3_f32 v252, v252, v135, v136
    v_fma_f32 v139, v139, s48, -v21
    v_mfma_f32_16x16x32_bf16 v[152:155], v[232:235], v[196:199], v[152:155]
    v_fma_f32 v140, v140, s48, -v22
    v_max3_f32 v252, v252, v137, v138
    s_waitcnt lgkmcnt(0)
    v_mfma_f32_16x16x32_bf16 v[144:147], v[236:239], v[168:171], v[144:147]
    v_fma_f32 v141, v141, s48, -v22
    v_fma_f32 v142, v142, s48, -v22
    v_mfma_f32_16x16x32_bf16 v[148:151], v[236:239], v[184:187], v[148:151]
    v_max3_f32 v252, v252, v139, v140
    v_fma_f32 v143, v143, s48, -v22
    v_mfma_f32_16x16x32_bf16 v[152:155], v[236:239], v[200:203], v[152:155]
    v_max3_f32 v252, v252, v141, v142
    v_max_f32 v252, v252, v143
    s_waitcnt vmcnt(8) lgkmcnt(0)
    s_mov_b64 exec, 1
    ds_add_u32 v2, v4 offset:12
    s_mov_b64 exec, -1
    s_add_u32 s61, s61, 2
    s_nop 4
    v_fma_f32 v144, v144, s48, -v20
    v_fma_f32 v145, v145, s48, -v20
    v_fma_f32 v146, v146, s48, -v20
    v_fma_f32 v147, v147, s48, -v20
    v_fma_f32 v148, v148, s48, -v21
    v_fma_f32 v149, v149, s48, -v21
    v_fma_f32 v150, v150, s48, -v21
    v_fma_f32 v151, v151, s48, -v21
    v_fma_f32 v152, v152, s48, -v22
    v_fma_f32 v153, v153, s48, -v22
    v_fma_f32 v154, v154, s48, -v22
    v_fma_f32 v155, v155, s48, -v22
L_p_24:
    ds_read_b32 v3, v2 offset:12
    s_waitcnt lgkmcnt(0)
    v_readfirstlane_b32 s31, v3
    s_cmp_ge_u32 s31, s61
    s_cbranch_scc1 L_q_25
    s_branch L_p_24
L_q_25:
    ds_read_b128 v[208:211], v8 offset:0
    ds_read_b128 v[212:215], v9 offset:0
    ds_read_b128 v[216:219], v10 offset:0
    ds_read_b128 v[220:223], v11 offset:0
    ds_read_b128 v[224:227], v8 offset:4096
    ds_read_b128 v[228:231], v9 offset:4096
    ds_read_b128 v[232:235], v10 offset:4096
    ds_read_b128 v[236:239], v11 offset:4096
    s_and_b32 s30, s22, 1
    s_cbranch_scc1 L_af_A0
    s_add_u32 m0, s53, s55
    s_nop 0
    buffer_load_dwordx4 v5, s[36:39], s51 offen offset:0 lds
    buffer_load_dwordx4 v6, s[36:39], s51 offen offset:1024 lds
    buffer_load_dwordx4 v5, s[36:39], s51 offen offset:2048 lds
    buffer_load_dwordx4 v6, s[36:39], s51 offen offset:3072 lds
    s_add_u32 m0, m0, 4096
    s_add_u32 s51, s51, 4096
    buffer_load_dwordx4 v5, s[36:39], s51 offen offset:0 lds
    buffer_load_dwordx4 v6, s[36:39], s51 offen offset:1024 lds
    buffer_load_dwordx4 v5, s[36:39], s51 offen offset:2048 lds
    buffer_load_dwordx4 v6, s[36:39], s51 offen offset:3072 lds
    s_add_u32 s51, s51, 4096
    s_and_b32 s51, s51, 0x3ffff
    s_sub_u32 s44, s44, 1
    s_cselect_b32 s38, 0, s38
    s_add_u32 s53, s53, 8192
    s_cmp_eq_u32 s53, s64
    s_cselect_b32 s53, 0, s53
L_af_A0:
    v_max3_f32 v240, v132, v133, v134
    v_max3_f32 v240, v240, v135, v144
    v_max3_f32 v240, v240, v145, v146
    v_max_f32 v240, v240, v147
    v_max3_f32 v241, v136, v137, v138
    v_max3_f32 v241, v241, v139, v148
    v_max3_f32 v241, v241, v149, v150
    v_max_f32 v241, v241, v151
    v_max3_f32 v242, v140, v141, v142
    v_max3_f32 v242, v242, v143, v152
    v_max3_f32 v242, v242, v153, v154
    v_max_f32 v242, v242, v155
    v_mov_b32 v243, v240
    v_mov_b32 v244, v241
    v_mov_b32 v245, v242
    v_permlane32_swap_b32 v240, v243
    v_permlane32_swap_b32 v241, v244
    v_permlane32_swap_b32 v242, v245
    s_nop 1
    v_max_f32 v240, v240, v243
    v_max_f32 v241, v241, v244
    v_max_f32 v242, v242, v245
    v_mov_b32 v243, v240
    v_mov_b32 v244, v241
    v_mov_b32 v245, v242
    v_permlane16_swap_b32 v240, v243
    v_permlane16_swap_b32 v241, v244
    v_permlane16_swap_b32 v242, v245
    s_nop 1
    v_max_f32 v240, v240, v243
    v_max_f32 v241, v241, v244
    v_max_f32 v242, v242, v245
    v_add_f32 v20, v20, v240
    v_sub_f32 v132, v132, v240
    v_sub_f32 v133, v133, v240
    v_sub_f32 v134, v134, v240
    v_sub_f32 v135, v135, v240
    v_sub_f32 v144, v144, v240
    v_sub_f32 v145, v145, v240
    v_sub_f32 v146, v146, v240
    v_sub_f32 v147, v147, v240
    v_add_f32 v21, v21, v241
    v_sub_f32 v136, v136, v241
    v_sub_f32 v137, v137, v241
    v_sub_f32 v138, v138, v241
    v_sub_f32 v139, v139, v241
    v_sub_f32 v148, v148, v241
    v_sub_f32 v149, v149, v241
    v_sub_f32 v150, v150, v241
    v_sub_f32 v151, v151, v241
    v_add_f32 v22, v22, v242
    v_sub_f32 v140, v140, v242
    v_sub_f32 v141, v141, v242
    v_sub_f32 v142, v142, v242
    v_sub_f32 v143, v143, v242
    v_sub_f32 v152, v152, v242
    v_sub_f32 v153, v153, v242
    v_sub_f32 v154, v154, v242
    v_sub_f32 v155, v155, v242
    v_exp_f32 v132, v132
    v_exp_f32 v133, v133
    v_exp_f32 v134, v134
    v_exp_f32 v135, v135
    v_exp_f32 v136, v136
    v_exp_f32 v137, v137
    v_exp_f32 v138, v138
    v_exp_f32 v139, v139
    v_exp_f32 v140, v140
    v_exp_f32 v141, v141
    v_exp_f32 v142, v142
    v_exp_f32 v143, v143
    v_cvt_pk_bf16_f32 v240, v132, v133
    v_cvt_pk_bf16_f32 v241, v134, v135
    v_cvt_pk_bf16_f32 v244, v136, v137
    v_cvt_pk_bf16_f32 v245, v138, v139
    v_cvt_pk_bf16_f32 v248, v140, v141
    v_cvt_pk_bf16_f32 v249, v142, v143
L_loopA:
    s_mov_b32 s59, s57
    s_add_u32 s57, s57, 8192
    s_cmp_eq_u32 s57, s64
    s_cselect_b32 s57, 0, s57
    s_sub_u32 s59, s57, s59
    s_waitcnt lgkmcnt(7)
    v_mfma_f32_16x16x32_bf16 v[132:135], v[208:211], v[156:159], 0
    v_exp_f32 v144, v144
    v_mfma_f32_16x16x32_bf16 v[136:139], v[208:211], v[172:175], 0
    v_exp_f32 v145, v145
    v_mfma_f32_16x16x32_bf16 v[140:143], v[208:211], v[188:191], 0
    v_exp_f32 v146, v146
    v_exp_f32 v147, v147
    ds_read_b64_tr_b16 v[208:209], v12 offset:0
    ds_read_b64_tr_b16 v[210:211], v12 offset:4096
    s_waitcnt lgkmcnt(8)
    v_mfma_f32_16x16x32_bf16 v[132:135], v[212:215], v[160:163], v[132:135]
    v_exp_f32 v148, v148
    v_mfma_f32_16x16x32_bf16 v[136:139], v[212:215], v[176:179], v[136:139]
    v_exp_f32 v149, v149
    v_mfma_f32_16x16x32_bf16 v[140:143], v[212:215], v[192:195], v[140:143]
    v_exp_f32 v150, v150
    v_exp_f32 v151, v151
    ds_read_b64_tr_b16 v[212:213], v13 offset:0
    ds_read_b64_tr_b16 v[214:215], v13 offset:4096
    s_waitcnt lgkmcnt(9)
    v_mfma_f32_16x16x32_bf16 v[132:135], v[216:219], v[164:167], v[132:135]
    v_exp_f32 v152, v152
    v_mfma_f32_16x16x32_bf16 v[136:139], v[216:219], v[180:183], v[136:139]
    v_exp_f32 v153, v153
    v_mfma_f32_16x16x32_bf16 v[140:143], v[216:219], v[196:199], v[140:143]
    v_exp_f32 v154, v154
    v_exp_f32 v155, v155
    ds_read_b64_tr_b16 v[216:217], v14 offset:0
    ds_read_b64_tr_b16 v[218:219], v14 offset:4096
    s_waitcnt lgkmcnt(6)
    v_mfma_f32_16x16x32_bf16 v[132:135], v[220:223], v[168:171], v[132:135]
    v_cvt_pk_bf16_f32 v242, v144, v145
    v_cvt_pk_bf16_f32 v243, v146, v147
    v_mfma_f32_16x16x32_bf16 v[136:139], v[220:223], v[184:187], v[136:139]
    v_cvt_pk_bf16_f32 v246, v148, v149
    v_cvt_pk_bf16_f32 v247, v150, v151
    v_mfma_f32_16x16x32_bf16 v[140:143], v[220:223], v[200:203], v[140:143]
    v_cvt_pk_bf16_f32 v250, v152, v153
    v_cvt_pk_bf16_f32 v251, v154, v155
    ds_read_b64_tr_b16 v[220:221], v15 offset:0
    ds_read_b64_tr_b16 v[222:223], v15 offset:4096
    s_waitcnt lgkmcnt(13)
    v_mfma_f32_16x16x32_bf16 v[144:147], v[224:227], v[156:159], 0
    v_add_u32 v8, s59, v8
    v_mfma_f32_16x16x32_bf16 v[148:151], v[224:227], v[172:175], 0
    v_add_u32 v9, s59, v9
    v_mfma_f32_16x16x32_bf16 v[152:155], v[224:227], v[188:191], 0
    v_add_u32 v10, s59, v10
    v_add_u32 v11, s59, v11
    ds_read_b64_tr_b16 v[224:225], v16 offset:0
    ds_read_b64_tr_b16 v[226:227], v16 offset:4096
    s_waitcnt lgkmcnt(13)
    v_mfma_f32_16x16x32_bf16 v[144:147], v[228:231], v[160:163], v[144:147]
    v_fma_f32 v132, v132, s48, -v20
    v_fma_f32 v133, v133, s48, -v20
    v_mfma_f32_16x16x32_bf16 v[148:151], v[228:231], v[176:179], v[148:151]
    v_fma_f32 v134, v134, s48, -v20
    v_fma_f32 v135, v135, s48, -v20
    v_mfma_f32_16x16x32_bf16 v[152:155], v[228:231], v[192:195], v[152:155]
    v_fma_f32 v136, v136, s48, -v21
    v_max3_f32 v252, v132, v133, v134
    ds_read_b64_tr_b16 v[228:229], v17 offset:0
    ds_read_b64_tr_b16 v[230:231], v17 offset:4096
    s_waitcnt lgkmcnt(13)
    v_mfma_f32_16x16x32_bf16 v[144:147], v[232:235], v[164:167], v[144:147]
    v_fma_f32 v137, v137, s48, -v21
    v_fma_f32 v138, v138, s48, -v21
    v_mfma_f32_16x16x32_bf16 v[148:151], v[232:235], v[180:183], v[148:151]
    v_max3_f32 v252, v252, v135, v136
    v_fma_f32 v139, v139, s48, -v21
    v_mfma_f32_16x16x32_bf16 v[152:155], v[232:235], v[196:199], v[152:155]
    v_fma_f32 v140, v140, s48, -v22
    v_max3_f32 v252, v252, v137, v138
    ds_read_b64_tr_b16 v[232:233], v18 offset:0
    ds_read_b64_tr_b16 v[234:235], v18 offset:4096
    s_waitcnt lgkmcnt(13)
    v_mfma_f32_16x16x32_bf16 v[144:147], v[236:239], v[168:171], v[144:147]
    v_fma_f32 v141, v141, s48, -v22
    v_fma_f32 v142, v142, s48, -v22
    v_mfma_f32_16x16x32_bf16 v[148:151], v[236:239], v[184:187], v[148:151]
    v_max3_f32 v252, v252, v139, v140
    v_fma_f32 v143, v143, s48, -v22
    v_mfma_f32_16x16x32_bf16 v[152:155], v[236:239], v[200:203], v[152:155]
    v_max3_f32 v252, v252, v141, v142
    v_max_f32 v252, v252, v143
    ds_read_b64_tr_b16 v[236:237], v19 offset:0
    ds_read_b64_tr_b16 v[238:239], v19 offset:4096
    s_waitcnt lgkmcnt(14)
    s_mov_b32 s60, s58
    s_add_u32 s58, s58, 8192
    s_cmp_eq_u32 s58, s65
    s_cselect_b32 s58, 0, s58
    s_sub_u32 s60, s58, s60
    v_mfma_f32_16x16x32_bf16 v[24:27], v[208:211], v[240:243], v[24:27]
    v_add_u32 v12, s60, v12
    v_mfma_f32_16x16x32_bf16 v[28:31], v[208:211], v[244:247], v[28:31]
    v_add_u32 v13, s60, v13
    v_mfma_f32_16x16x32_bf16 v[32:35], v[208:211], v[248:251], v[32:35]
    v_add_u32 v14, s60, v14
    v_add_u32 v15, s60, v15
    s_waitcnt lgkmcnt(12)
    v_mfma_f32_16x16x32_bf16 v[36:39], v[212:215], v[240:243], v[36:39]
    v_fma_f32 v144, v144, s48, -v20
    v_fma_f32 v145, v145, s48, -v20
    v_mfma_f32_16x16x32_bf16 v[40:43], v[212:215], v[244:247], v[40:43]
    v_fma_f32 v146, v146, s48, -v20
    v_fma_f32 v147, v147, s48, -v20
    v_fma_f32 v148, v148, s48, -v21
    v_mfma_f32_16x16x32_bf16 v[44:47], v[212:215], v[248:251], v[44:47]
    v_max3_f32 v253, v144, v145, v146
    v_fma_f32 v149, v149, s48, -v21
    v_fma_f32 v150, v150, s48, -v21
    s_waitcnt lgkmcnt(0)
    s_waitcnt vmcnt(8) lgkmcnt(0)
    s_mov_b64 exec, 1
    ds_add_u32 v2, v4 offset:12
    s_mov_b64 exec, -1
    s_add_u32 s61, s61, 2
    v_mfma_f32_16x16x32_bf16 v[48:51], v[216:219], v[240:243], v[48:51]
    v_max3_f32 v253, v253, v147, v148
    v_fma_f32 v151, v151, s48, -v21
    v_fma_f32 v152, v152, s48, -v22
    v_mfma_f32_16x16x32_bf16 v[52:55], v[216:219], v[244:247], v[52:55]
    v_max3_f32 v253, v253, v149, v150
    v_fma_f32 v153, v153, s48, -v22
    v_fma_f32 v154, v154, s48, -v22
    v_mfma_f32_16x16x32_bf16 v[56:59], v[216:219], v[248:251], v[56:59]
    v_max3_f32 v253, v253, v151, v152
    v_fma_f32 v155, v155, s48, -v22
    v_max3_f32 v253, v253, v153, v154
    v_max3_f32 v253, v253, v155, v252
    v_cmp_nge_f32 vcc, s49, v253
    s_cbranch_vccnz L_rare_A1
    v_mfma_f32_16x16x32_bf16 v[60:63], v[220:223], v[240:243], v[60:63]
    v_exp_f32 v132, v132
    v_exp_f32 v133, v133
    v_mfma_f32_16x16x32_bf16 v[64:67], v[220:223], v[244:247], v[64:67]
    v_add_u32 v16, s60, v16
    v_add_u32 v17, s60, v17
    v_mfma_f32_16x16x32_bf16 v[68:71], v[220:223], v[248:251], v[68:71]
    v_add_u32 v18, s60, v18
    v_add_u32 v19, s60, v19
L_p_26:
    ds_read_b32 v3, v2 offset:12
    s_waitcnt lgkmcnt(0)
    v_readfirstlane_b32 s31, v3
    s_cmp_ge_u32 s31, s61
    s_cbranch_scc1 L_q_27
    s_branch L_p_26
L_q_27:
    ds_read_b128 v[208:211], v8 offset:0
    ds_read_b128 v[212:215], v9 offset:0
    ds_read_b128 v[216:219], v10 offset:0
    ds_read_b128 v[220:223], v11 offset:0
    v_mfma_f32_16x16x32_bf16 v[72:75], v[224:227], v[240:243], v[72:75]
    v_mfma_f32_16x16x32_bf16 v[76:79], v[224:227], v[244:247], v[76:79]
    v_exp_f32 v134, v134
    v_mfma_f32_16x16x32_bf16 v[80:83], v[224:227], v[248:251], v[80:83]
    v_exp_f32 v135, v135
    ds_read_b128 v[224:227], v8 offset:4096
    s_add_u32 m0, s53, s55
    s_nop 0
    buffer_load_dwordx4 v5, s[36:39], s51 offen offset:0 lds
    buffer_load_dwordx4 v6, s[36:39], s51 offen offset:1024 lds
    v_mfma_f32_16x16x32_bf16 v[84:87], v[228:231], v[240:243], v[84:87]
    v_mfma_f32_16x16x32_bf16 v[88:91], v[228:231], v[244:247], v[88:91]
    v_exp_f32 v136, v136
    v_mfma_f32_16x16x32_bf16 v[92:95], v[228:231], v[248:251], v[92:95]
    v_exp_f32 v137, v137
    ds_read_b128 v[228:231], v9 offset:4096
    buffer_load_dwordx4 v5, s[36:39], s51 offen offset:2048 lds
    buffer_load_dwordx4 v6, s[36:39], s51 offen offset:3072 lds
    v_mfma_f32_16x16x32_bf16 v[96:99], v[232:235], v[240:243], v[96:99]
    v_mfma_f32_16x16x32_bf16 v[100:103], v[232:235], v[244:247], v[100:103]
    v_exp_f32 v138, v138
    v_mfma_f32_16x16x32_bf16 v[104:107], v[232:235], v[248:251], v[104:107]
    v_exp_f32 v139, v139
    ds_read_b128 v[232:235], v10 offset:4096
    s_add_u32 m0, m0, 4096
    s_add_u32 s51, s51, 4096
    buffer_load_dwordx4 v5, s[36:39], s51 offen offset:0 lds
    buffer_load_dwordx4 v6, s[36:39], s51 offen offset:1024 lds
    v_mfma_f32_16x16x32_bf16 v[108:111], v[236:239], v[240:243], v[108:111]
    v_mfma_f32_16x16x32_bf16 v[112:115], v[236:239], v[244:247], v[112:115]
    v_exp_f32 v140, v140
    v_mfma_f32_16x16x32_bf16 v[116:119], v[236:239], v[248:251], v[116:119]
    v_exp_f32 v141, v141
    ds_read_b128 v[236:239], v11 offset:4096
    buffer_load_dwordx4 v5, s[36:39], s51 offen offset:2048 lds
    buffer_load_dwordx4 v6, s[36:39], s51 offen offset:3072 lds
    v_mfma_f32_16x16x32_bf16 v[120:123], v[204:207], v[240:243], v[120:123]
    v_mfma_f32_16x16x32_bf16 v[124:127], v[204:207], v[244:247], v[124:127]
    v_exp_f32 v142, v142
    v_mfma_f32_16x16x32_bf16 v[128:131], v[204:207], v[248:251], v[128:131]
    v_exp_f32 v143, v143
    s_add_u32 s51, s51, 4096
    s_and_b32 s51, s51, 0x3ffff
    s_sub_u32 s44, s44, 1
    s_cselect_b32 s38, 0, s38
    s_add_u32 s53, s53, 8192
    s_cmp_eq_u32 s53, s64
    s_cselect_b32 s53, 0, s53
L_join_A1:
    s_nop 0
    v_cvt_pk_bf16_f32 v240, v132, v133
    v_cvt_pk_bf16_f32 v241, v134, v135
    v_cvt_pk_bf16_f32 v244, v136, v137
    v_cvt_pk_bf16_f32 v245, v138, v139
    v_cvt_pk_bf16_f32 v248, v140, v141
    v_cvt_pk_bf16_f32 v249, v142, v143
    s_add_u32 s50, s50, 1
    s_cmp_lt_u32 s50, 31
    s_cbranch_scc1 L_loopA
    ds_write_b32 v2, v2 offset:96
    s_waitcnt lgkmcnt(0)
    s_mov_b32 s59, s57
    s_add_u32 s57, s57, 8192
    s_cmp_eq_u32 s57, s64
    s_cselect_b32 s57, 0, s57
    s_sub_u32 s59, s57, s59
    s_waitcnt lgkmcnt(7)
    v_mfma_f32_16x16x32_bf16 v[132:135], v[208:211], v[156:159], 0
    v_exp_f32 v144, v144
    v_mfma_f32_16x16x32_bf16 v[136:139], v[208:211], v[172:175], 0
    v_exp_f32 v145, v145
    v_mfma_f32_16x16x32_bf16 v[140:143], v[208:211], v[188:191], 0
    v_exp_f32 v146, v146
    v_exp_f32 v147, v147
    ds_read_b64_tr_b16 v[208:209], v12 offset:0
    ds_read_b64_tr_b16 v[210:211], v12 offset:4096
    s_waitcnt lgkmcnt(8)
    v_mfma_f32_16x16x32_bf16 v[132:135], v[212:215], v[160:163], v[132:135]
    v_exp_f32 v148, v148
    v_mfma_f32_16x16x32_bf16 v[136:139], v[212:215], v[176:179], v[136:139]
    v_exp_f32 v149, v149
    v_mfma_f32_16x16x32_bf16 v[140:143], v[212:215], v[192:195], v[140:143]
    v_exp_f32 v150, v150
    v_exp_f32 v151, v151
    ds_read_b64_tr_b16 v[212:213], v13 offset:0
    ds_read_b64_tr_b16 v[214:215], v13 offset:4096
    s_waitcnt lgkmcnt(9)
    v_mfma_f32_16x16x32_bf16 v[132:135], v[216:219], v[164:167], v[132:135]
    v_exp_f32 v152, v152
    v_mfma_f32_16x16x32_bf16 v[136:139], v[216:219], v[180:183], v[136:139]
    v_exp_f32 v153, v153
    v_mfma_f32_16x16x32_bf16 v[140:143], v[216:219], v[196:199], v[140:143]
    v_exp_f32 v154, v154
    v_exp_f32 v155, v155
    ds_read_b64_tr_b16 v[216:217], v14 offset:0
    ds_read_b64_tr_b16 v[218:219], v14 offset:4096
    s_waitcnt lgkmcnt(6)
    v_mfma_f32_16x16x32_bf16 v[132:135], v[220:223], v[168:171], v[132:135]
    v_cvt_pk_bf16_f32 v242, v144, v145
    v_cvt_pk_bf16_f32 v243, v146, v147
    v_mfma_f32_16x16x32_bf16 v[136:139], v[220:223], v[184:187], v[136:139]
    v_cvt_pk_bf16_f32 v246, v148, v149
    v_cvt_pk_bf16_f32 v247, v150, v151
    v_mfma_f32_16x16x32_bf16 v[140:143], v[220:223], v[200:203], v[140:143]
    v_cvt_pk_bf16_f32 v250, v152, v153
    v_cvt_pk_bf16_f32 v251, v154, v155
    ds_read_b64_tr_b16 v[220:221], v15 offset:0
    ds_read_b64_tr_b16 v[222:223], v15 offset:4096
    s_waitcnt lgkmcnt(13)
    v_mfma_f32_16x16x32_bf16 v[144:147], v[224:227], v[156:159], 0
    v_add_u32 v8, s59, v8
    v_mfma_f32_16x16x32_bf16 v[148:151], v[224:227], v[172:175], 0
    v_add_u32 v9, s59, v9
    v_mfma_f32_16x16x32_bf16 v[152:155], v[224:227], v[188:191], 0
    v_add_u32 v10, s59, v10
    v_add_u32 v11, s59, v11
    ds_read_b64_tr_b16 v[224:225], v16 offset:0
    ds_read_b64_tr_b16 v[226:227], v16 offset:4096
    s_waitcnt lgkmcnt(13)
    v_mfma_f32_16x16x32_bf16 v[144:147], v[228:231], v[160:163], v[144:147]
    v_fma_f32 v132, v132, s48, -v20
    v_fma_f32 v133, v133, s48, -v20
    v_mfma_f32_16x16x32_bf16 v[148:151], v[228:231], v[176:179], v[148:151]
    v_fma_f32 v134, v134, s48, -v20
    v_fma_f32 v135, v135, s48, -v20
    v_mfma_f32_16x16x32_bf16 v[152:155], v[228:231], v[192:195], v[152:155]
    v_fma_f32 v136, v136, s48, -v21
    v_max3_f32 v252, v132, v133, v134
    ds_read_b64_tr_b16 v[228:229], v17 offset:0
    ds_read_b64_tr_b16 v[230:231], v17 offset:4096
    s_waitcnt lgkmcnt(13)
    v_mfma_f32_16x16x32_bf16 v[144:147], v[232:235], v[164:167], v[144:147]
    v_fma_f32 v137, v137, s48, -v21
    v_fma_f32 v138, v138, s48, -v21
    v_mfma_f32_16x16x32_bf16 v[148:151], v[232:235], v[180:183], v[148:151]
    v_max3_f32 v252, v252, v135, v136
    v_fma_f32 v139, v139, s48, -v21
    v_mfma_f32_16x16x32_bf16 v[152:155], v[232:235], v[196:199], v[152:155]
    v_fma_f32 v140, v140, s48, -v22
    v_max3_f32 v252, v252, v137, v138
    ds_read_b64_tr_b16 v[232:233], v18 offset:0
    ds_read_b64_tr_b16 v[234:235], v18 offset:4096
    s_waitcnt lgkmcnt(13)
    v_mfma_f32_16x16x32_bf16 v[144:147], v[236:239], v[168:171], v[144:147]
    v_fma_f32 v141, v141, s48, -v22
    v_fma_f32 v142, v142, s48, -v22
    v_mfma_f32_16x16x32_bf16 v[148:151], v[236:239], v[184:187], v[148:151]
    v_max3_f32 v252, v252, v139, v140
    v_fma_f32 v143, v143, s48, -v22
    v_mfma_f32_16x16x32_bf16 v[152:155], v[236:239], v[200:203], v[152:155]
    v_max3_f32 v252, v252, v141, v142
    v_max_f32 v252, v252, v143
    ds_read_b64_tr_b16 v[236:237], v19 offset:0
    ds_read_b64_tr_b16 v[238:239], v19 offset:4096
    s_waitcnt lgkmcnt(14)
    s_mov_b32 s60, s58
    s_add_u32 s58, s58, 8192
    s_cmp_eq_u32 s58, s65
    s_cselect_b32 s58, 0, s58
    s_sub_u32 s60, s58, s60
    v_mfma_f32_16x16x32_bf16 v[24:27], v[208:211], v[240:243], v[24:27]
    v_add_u32 v12, s60, v12
    v_mfma_f32_16x16x32_bf16 v[28:31], v[208:211], v[244:247], v[28:31]
    v_add_u32 v13, s60, v13
    v_mfma_f32_16x16x32_bf16 v[32:35], v[208:211], v[248:251], v[32:35]
    v_add_u32 v14, s60, v14
    v_add_u32 v15, s60, v15
    s_waitcnt lgkmcnt(12)
    v_mfma_f32_16x16x32_bf16 v[36:39], v[212:215], v[240:243], v[36:39]
    v_fma_f32 v144, v144, s48, -v20
    v_fma_f32 v145, v145, s48, -v20
    v_mfma_f32_16x16x32_bf16 v[40:43], v[212:215], v[244:247], v[40:43]
    v_fma_f32 v146, v146, s48, -v20
    v_fma_f32 v147, v147, s48, -v20
    v_fma_f32 v148, v148, s48, -v21
    v_mfma_f32_16x16x32_bf16 v[44:47], v[212:215], v[248:251], v[44:47]
    v_max3_f32 v253, v144, v145, v146
    v_fma_f32 v149, v149, s48, -v21
    v_fma_f32 v150, v150, s48, -v21
    s_waitcnt lgkmcnt(0)
    s_waitcnt vmcnt(8) lgkmcnt(0)
    s_mov_b64 exec, 1
    ds_add_u32 v2, v4 offset:12
    s_mov_b64 exec, -1
    s_add_u32 s61, s61, 2
    v_mfma_f32_16x16x32_bf16 v[48:51], v[216:219], v[240:243], v[48:51]
    v_max3_f32 v253, v253, v147, v148
    v_fma_f32 v151, v151, s48, -v21
    v_fma_f32 v152, v152, s48, -v22
    v_mfma_f32_16x16x32_bf16 v[52:55], v[216:219], v[244:247], v[52:55]
    v_max3_f32 v253, v253, v149, v150
    v_fma_f32 v153, v153, s48, -v22
    v_fma_f32 v154, v154, s48, -v22
    v_mfma_f32_16x16x32_bf16 v[56:59], v[216:219], v[248:251], v[56:59]
    v_max3_f32 v253, v253, v151, v152
    v_fma_f32 v155, v155, s48, -v22
    v_max3_f32 v253, v253, v153, v154
    v_max3_f32 v253, v253, v155, v252
    v_cmp_nge_f32 vcc, s49, v253
    s_cbranch_vccnz L_rare_A2
    v_mfma_f32_16x16x32_bf16 v[60:63], v[220:223], v[240:243], v[60:63]
    v_exp_f32 v132, v132
    v_exp_f32 v133, v133
    v_mfma_f32_16x16x32_bf16 v[64:67], v[220:223], v[244:247], v[64:67]
    v_add_u32 v16, s60, v16
    v_add_u32 v17, s60, v17
    v_mfma_f32_16x16x32_bf16 v[68:71], v[220:223], v[248:251], v[68:71]
    v_add_u32 v18, s60, v18
    v_add_u32 v19, s60, v19
L_p_28:
    ds_read_b32 v3, v2 offset:12
    s_waitcnt lgkmcnt(0)
    v_readfirstlane_b32 s31, v3
    s_cmp_ge_u32 s31, s61
    s_cbranch_scc1 L_q_29
    s_branch L_p_28
L_q_29:
    v_mfma_f32_16x16x32_bf16 v[72:75], v[224:227], v[240:243], v[72:75]
    v_mfma_f32_16x16x32_bf16 v[76:79], v[224:227], v[244:247], v[76:79]
    v_exp_f32 v134, v134
    v_mfma_f32_16x16x32_bf16 v[80:83], v[224:227], v[248:251], v[80:83]
    v_exp_f32 v135, v135
    s_add_u32 m0, s53, s55
    s_nop 0
    buffer_load_dwordx4 v5, s[36:39], s51 offen offset:0 lds
    buffer_load_dwordx4 v6, s[36:39], s51 offen offset:1024 lds
    v_mfma_f32_16x16x32_bf16 v[84:87], v[228:231], v[240:243], v[84:87]
    v_mfma_f32_16x16x32_bf16 v[88:91], v[228:231], v[244:247], v[88:91]
    v_exp_f32 v136, v136
    v_mfma_f32_16x16x32_bf16 v[92:95], v[228:231], v[248:251], v[92:95]
    v_exp_f32 v137, v137
    buffer_load_dwordx4 v5, s[36:39], s51 offen offset:2048 lds
    buffer_load_dwordx4 v6, s[36:39], s51 offen offset:3072 lds
    v_mfma_f32_16x16x32_bf16 v[96:99], v[232:235], v[240:243], v[96:99]
    v_mfma_f32_16x16x32_bf16 v[100:103], v[232:235], v[244:247], v[100:103]
    v_exp_f32 v138, v138
    v_mfma_f32_16x16x32_bf16 v[104:107], v[232:235], v[248:251], v[104:107]
    v_exp_f32 v139, v139
    s_add_u32 m0, m0, 4096
    s_add_u32 s51, s51, 4096
    buffer_load_dwordx4 v5, s[36:39], s51 offen offset:0 lds
    buffer_load_dwordx4 v6, s[36:39], s51 offen offset:1024 lds
    v_mfma_f32_16x16x32_bf16 v[108:111], v[236:239], v[240:243], v[108:111]
    v_mfma_f32_16x16x32_bf16 v[112:115], v[236:239], v[244:247], v[112:115]
    v_exp_f32 v140, v140
    v_mfma_f32_16x16x32_bf16 v[116:119], v[236:239], v[248:251], v[116:119]
    v_exp_f32 v141, v141
    buffer_load_dwordx4 v5, s[36:39], s51 offen offset:2048 lds
    buffer_load_dwordx4 v6, s[36:39], s51 offen offset:3072 lds
    v_mfma_f32_16x16x32_bf16 v[120:123], v[204:207], v[240:243], v[120:123]
    v_mfma_f32_16x16x32_bf16 v[124:127], v[204:207], v[244:247], v[124:127]
    v_exp_f32 v142, v142
    v_mfma_f32_16x16x32_bf16 v[128:131], v[204:207], v[248:251], v[128:131]
    v_exp_f32 v143, v143
    s_add_u32 s51, s51, 4096
    s_and_b32 s51, s51, 0x3ffff
    s_sub_u32 s44, s44, 1
    s_cselect_b32 s38, 0, s38
    s_add_u32 s53, s53, 8192
    s_cmp_eq_u32 s53, s64
    s_cselect_b32 s53, 0, s53
L_join_A2:
    s_nop 0
    v_cvt_pk_bf16_f32 v240, v132, v133
    v_cvt_pk_bf16_f32 v241, v134, v135
    v_cvt_pk_bf16_f32 v244, v136, v137
    v_cvt_pk_bf16_f32 v245, v138, v139
    v_cvt_pk_bf16_f32 v248, v140, v141
    v_cvt_pk_bf16_f32 v249, v142, v143
    ds_read_b64_tr_b16 v[208:209], v12 offset:0
    ds_read_b64_tr_b16 v[210:211], v12 offset:4096
    ds_read_b64_tr_b16 v[212:213], v13 offset:0
    ds_read_b64_tr_b16 v[214:215], v13 offset:4096
    ds_read_b64_tr_b16 v[216:217], v14 offset:0
    ds_read_b64_tr_b16 v[218:219], v14 offset:4096
    ds_read_b64_tr_b16 v[220:221], v15 offset:0
    ds_read_b64_tr_b16 v[222:223], v15 offset:4096
    ds_read_b64_tr_b16 v[224:225], v16 offset:0
    ds_read_b64_tr_b16 v[226:227], v16 offset:4096
    ds_read_b64_tr_b16 v[228:229], v17 offset:0
    ds_read_b64_tr_b16 v[230:231], v17 offset:4096
    ds_read_b64_tr_b16 v[232:233], v18 offset:0
    ds_read_b64_tr_b16 v[234:235], v18 offset:4096
    v_exp_f32 v144, v144
    v_exp_f32 v145, v145
    v_exp_f32 v146, v146
    v_exp_f32 v147, v147
    v_exp_f32 v148, v148
    v_exp_f32 v149, v149
    v_exp_f32 v150, v150
    v_exp_f32 v151, v151
    v_exp_f32 v152, v152
    v_exp_f32 v153, v153
    v_exp_f32 v154, v154
    v_exp_f32 v155, v155
    s_waitcnt lgkmcnt(6)
    ds_read_b64_tr_b16 v[236:237], v19 offset:0
    ds_read_b64_tr_b16 v[238:239], v19 offset:4096
    v_cvt_pk_bf16_f32 v242, v144, v145
    v_cvt_pk_bf16_f32 v243, v146, v147
    v_cvt_pk_bf16_f32 v246, v148, v149
    v_cvt_pk_bf16_f32 v247, v150, v151
    v_cvt_pk_bf16_f32 v250, v152, v153
    v_cvt_pk_bf16_f32 v251, v154, v155
    s_waitcnt lgkmcnt(0)
    v_mfma_f32_16x16x32_bf16 v[24:27], v[208:211], v[240:243], v[24:27]
    v_mfma_f32_16x16x32_bf16 v[28:31], v[208:211], v[244:247], v[28:31]
    v_mfma_f32_16x16x32_bf16 v[32:35], v[208:211], v[248:251], v[32:35]
    v_mfma_f32_16x16x32_bf16 v[36:39], v[212:215], v[240:243], v[36:39]
    v_mfma_f32_16x16x32_bf16 v[40:43], v[212:215], v[244:247], v[40:43]
    v_mfma_f32_16x16x32_bf16 v[44:47], v[212:215], v[248:251], v[44:47]
    v_mfma_f32_16x16x32_bf16 v[48:51], v[216:219], v[240:243], v[48:51]
    v_mfma_f32_16x16x32_bf16 v[52:55], v[216:219], v[244:247], v[52:55]
    v_mfma_f32_16x16x32_bf16 v[56:59], v[216:219], v[248:251], v[56:59]
    v_mfma_f32_16x16x32_bf16 v[60:63], v[220:223], v[240:243], v[60:63]
    v_mfma_f32_16x16x32_bf16 v[64:67], v[220:223], v[244:247], v[64:67]
    v_mfma_f32_16x16x32_bf16 v[68:71], v[220:223], v[248:251], v[68:71]
    v_mfma_f32_16x16x32_bf16 v[72:75], v[224:227], v[240:243], v[72:75]
    v_mfma_f32_16x16x32_bf16 v[76:79], v[224:227], v[244:247], v[76:79]
    v_mfma_f32_16x16x32_bf16 v[80:83], v[224:227], v[248:251], v[80:83]
    v_mfma_f32_16x16x32_bf16 v[84:87], v[228:231], v[240:243], v[84:87]
    v_mfma_f32_16x16x32_bf16 v[88:91], v[228:231], v[244:247], v[88:91]
    v_mfma_f32_16x16x32_bf16 v[92:95], v[228:231], v[248:251], v[92:95]
    v_mfma_f32_16x16x32_bf16 v[96:99], v[232:235], v[240:243], v[96:99]
    v_mfma_f32_16x16x32_bf16 v[100:103], v[232:235], v[244:247], v[100:103]
    v_mfma_f32_16x16x32_bf16 v[104:107], v[232:235], v[248:251], v[104:107]
    v_mfma_f32_16x16x32_bf16 v[108:111], v[236:239], v[240:243], v[108:111]
    v_mfma_f32_16x16x32_bf16 v[112:115], v[236:239], v[244:247], v[112:115]
    v_mfma_f32_16x16x32_bf16 v[116:119], v[236:239], v[248:251], v[116:119]
    v_mfma_f32_16x16x32_bf16 v[120:123], v[204:207], v[240:243], v[120:123]
    v_mfma_f32_16x16x32_bf16 v[124:127], v[204:207], v[244:247], v[124:127]
    v_mfma_f32_16x16x32_bf16 v[128:131], v[204:207], v[248:251], v[128:131]
    s_waitcnt lgkmcnt(0)
    s_mov_b64 exec, 1
    ds_add_u32 v2, v4 offset:12
    s_mov_b64 exec, -1
    s_add_u32 s61, s61, 2
L_p_30:
    ds_read_b32 v3, v2 offset:12
    s_waitcnt lgkmcnt(0)
    v_readfirstlane_b32 s31, v3
    s_cmp_ge_u32 s31, s61
    s_cbranch_scc1 L_q_31
    s_branch L_p_30
L_q_31:
L_out:
    s_nop 7
    v_rcp_f32 v240, v120
    v_rcp_f32 v241, v124
    v_rcp_f32 v242, v128
    v_add_u32 v7, s55, v1
    s_waitcnt vmcnt(0)
    v_mul_f32 v24, v24, v240
    v_mul_f32 v25, v25, v240
    v_mul_f32 v26, v26, v240
    v_mul_f32 v27, v27, v240
    v_mul_f32 v36, v36, v240
    v_mul_f32 v37, v37, v240
    v_mul_f32 v38, v38, v240
    v_mul_f32 v39, v39, v240
    v_cvt_pk_bf16_f32 v156, v24, v25
    v_cvt_pk_bf16_f32 v157, v26, v27
    v_cvt_pk_bf16_f32 v158, v36, v37
    v_cvt_pk_bf16_f32 v159, v38, v39
    ds_write_b128 v7, v[156:159] offset:0
    v_mul_f32 v28, v28, v241
    v_mul_f32 v29, v29, v241
    v_mul_f32 v30, v30, v241
    v_mul_f32 v31, v31, v241
    v_mul_f32 v40, v40, v241
    v_mul_f32 v41, v41, v241
    v_mul_f32 v42, v42, v241
    v_mul_f32 v43, v43, v241
    v_cvt_pk_bf16_f32 v172, v28, v29
    v_cvt_pk_bf16_f32 v173, v30, v31
    v_cvt_pk_bf16_f32 v174, v40, v41
    v_cvt_pk_bf16_f32 v175, v42, v43
    ds_write_b128 v7, v[172:175] offset:4096
    v_mul_f32 v32, v32, v242
    v_mul_f32 v33, v33, v242
    v_mul_f32 v34, v34, v242
    v_mul_f32 v35, v35, v242
    v_mul_f32 v44, v44, v242
    v_mul_f32 v45, v45, v242
    v_mul_f32 v46, v46, v242
    v_mul_f32 v47, v47, v242
    v_cvt_pk_bf16_f32 v188, v32, v33
    v_cvt_pk_bf16_f32 v189, v34, v35
    v_cvt_pk_bf16_f32 v190, v44, v45
    v_cvt_pk_bf16_f32 v191, v46, v47
    ds_write_b128 v7, v[188:191] offset:8192
    v_mul_f32 v48, v48, v240
    v_mul_f32 v49, v49, v240
    v_mul_f32 v50, v50, v240
    v_mul_f32 v51, v51, v240
    v_mul_f32 v60, v60, v240
    v_mul_f32 v61, v61, v240
    v_mul_f32 v62, v62, v240
    v_mul_f32 v63, v63, v240
    v_cvt_pk_bf16_f32 v160, v48, v49
    v_cvt_pk_bf16_f32 v161, v50, v51
    v_cvt_pk_bf16_f32 v162, v60, v61
    v_cvt_pk_bf16_f32 v163, v62, v63
    ds_write_b128 v7, v[160:163] offset:1024
    v_mul_f32 v52, v52, v241
    v_mul_f32 v53, v53, v241
    v_mul_f32 v54, v54, v241
    v_mul_f32 v55, v55, v241
    v_mul_f32 v64, v64, v241
    v_mul_f32 v65, v65, v241
    v_mul_f32 v66, v66, v241
    v_mul_f32 v67, v67, v241
    v_cvt_pk_bf16_f32 v176, v52, v53
    v_cvt_pk_bf16_f32 v177, v54, v55
    v_cvt_pk_bf16_f32 v178, v64, v65
    v_cvt_pk_bf16_f32 v179, v66, v67
    ds_write_b128 v7, v[176:179] offset:5120
    v_mul_f32 v56, v56, v242
    v_mul_f32 v57, v57, v242
    v_mul_f32 v58, v58, v242
    v_mul_f32 v59, v59, v242
    v_mul_f32 v68, v68, v242
    v_mul_f32 v69, v69, v242
    v_mul_f32 v70, v70, v242
    v_mul_f32 v71, v71, v242
    v_cvt_pk_bf16_f32 v192, v56, v57
    v_cvt_pk_bf16_f32 v193, v58, v59
    v_cvt_pk_bf16_f32 v194, v68, v69
    v_cvt_pk_bf16_f32 v195, v70, v71
    ds_write_b128 v7, v[192:195] offset:9216
    v_mul_f32 v72, v72, v240
    v_mul_f32 v73, v73, v240
    v_mul_f32 v74, v74, v240
    v_mul_f32 v75, v75, v240
    v_mul_f32 v84, v84, v240
    v_mul_f32 v85, v85, v240
    v_mul_f32 v86, v86, v240
    v_mul_f32 v87, v87, v240
    v_cvt_pk_bf16_f32 v164, v72, v73
    v_cvt_pk_bf16_f32 v165, v74, v75
    v_cvt_pk_bf16_f32 v166, v84, v85
    v_cvt_pk_bf16_f32 v167, v86, v87
    ds_write_b128 v7, v[164:167] offset:2048
    v_mul_f32 v76, v76, v241
    v_mul_f32 v77, v77, v241
    v_mul_f32 v78, v78, v241
    v_mul_f32 v79, v79, v241
    v_mul_f32 v88, v88, v241
    v_mul_f32 v89, v89, v241
    v_mul_f32 v90, v90, v241
    v_mul_f32 v91, v91, v241
    v_cvt_pk_bf16_f32 v180, v76, v77
    v_cvt_pk_bf16_f32 v181, v78, v79
    v_cvt_pk_bf16_f32 v182, v88, v89
    v_cvt_pk_bf16_f32 v183, v90, v91
    ds_write_b128 v7, v[180:183] offset:6144
    v_mul_f32 v80, v80, v242
    v_mul_f32 v81, v81, v242
    v_mul_f32 v82, v82, v242
    v_mul_f32 v83, v83, v242
    v_mul_f32 v92, v92, v242
    v_mul_f32 v93, v93, v242
    v_mul_f32 v94, v94, v242
    v_mul_f32 v95, v95, v242
    v_cvt_pk_bf16_f32 v196, v80, v81
    v_cvt_pk_bf16_f32 v197, v82, v83
    v_cvt_pk_bf16_f32 v198, v92, v93
    v_cvt_pk_bf16_f32 v199, v94, v95
    ds_write_b128 v7, v[196:199] offset:10240
    v_mul_f32 v96, v96, v240
    v_mul_f32 v97, v97, v240
    v_mul_f32 v98, v98, v240
    v_mul_f32 v99, v99, v240
    v_mul_f32 v108, v108, v240
    v_mul_f32 v109, v109, v240
    v_mul_f32 v110, v110, v240
    v_mul_f32 v111, v111, v240
    v_cvt_pk_bf16_f32 v168, v96, v97
    v_cvt_pk_bf16_f32 v169, v98, v99
    v_cvt_pk_bf16_f32 v170, v108, v109
    v_cvt_pk_bf16_f32 v171, v110, v111
    ds_write_b128 v7, v[168:171] offset:3072
    v_mul_f32 v100, v100, v241
    v_mul_f32 v101, v101, v241
    v_mul_f32 v102, v102, v241
    v_mul_f32 v103, v103, v241
    v_mul_f32 v112, v112, v241
    v_mul_f32 v113, v113, v241
    v_mul_f32 v114, v114, v241
    v_mul_f32 v115, v115, v241
    v_cvt_pk_bf16_f32 v184, v100, v101
    v_cvt_pk_bf16_f32 v185, v102, v103
    v_cvt_pk_bf16_f32 v186, v112, v113
    v_cvt_pk_bf16_f32 v187, v114, v115
    ds_write_b128 v7, v[184:187] offset:7168
    v_mul_f32 v104, v104, v242
    v_mul_f32 v105, v105, v242
    v_mul_f32 v106, v106, v242
    v_mul_f32 v107, v107, v242
    v_mul_f32 v116, v116, v242
    v_mul_f32 v117, v117, v242
    v_mul_f32 v118, v118, v242
    v_mul_f32 v119, v119, v242
    v_cvt_pk_bf16_f32 v200, v104, v105
    v_cvt_pk_bf16_f32 v201, v106, v107
    v_cvt_pk_bf16_f32 v202, v116, v117
    v_cvt_pk_bf16_f32 v203, v118, v119
    ds_write_b128 v7, v[200:203] offset:11264
    s_lshl_b32 s30, s22, 2
    v_mov_b32 v7, s30
    s_waitcnt lgkmcnt(0)
    ds_write_b32 v7, v4 offset:64
    s_waitcnt lgkmcnt(0)
    s_setprio 2
    s_mov_b32 s55, 0
    s_mov_b32 s57, 1
    s_mov_b32 s90, 32
    s_mov_b32 s97, 1
    s_branch G_oset
    s_branch K_end
L_rare_B1:
    s_cmp_eq_u32 s66, 0
    s_cbranch_scc1 L_th_32
    s_waitcnt vmcnt(6)
L_th_32:
    s_add_u32 m0, s54, s56
    s_nop 0
    buffer_load_dwordx4 v5, s[40:43], s52 offen offset:0 nt lds
    buffer_load_dwordx4 v6, s[40:43], s52 offen offset:1024 nt lds
    buffer_load_dwordx4 v5, s[40:43], s52 offen offset:2048 nt lds
    buffer_load_dwordx4 v6, s[40:43], s52 offen offset:3072 nt lds
    v_mfma_f32_16x16x32_bf16 v[60:63], v[220:223], v[240:243], v[60:63]
    v_add_u32 v16, s60, v16
    v_mfma_f32_16x16x32_bf16 v[64:67], v[220:223], v[244:247], v[64:67]
    v_add_u32 v17, s60, v17
    v_mfma_f32_16x16x32_bf16 v[68:71], v[220:223], v[248:251], v[68:71]
    v_add_u32 v18, s60, v18
    v_add_u32 v19, s60, v19
    s_add_u32 m0, m0, 4096
    s_add_u32 s52, s52, 4096
    buffer_load_dwordx4 v5, s[40:43], s52 offen offset:0 nt lds
    buffer_load_dwordx4 v6, s[40:43], s52 offen offset:1024 nt lds
    buffer_load_dwordx4 v5, s[40:43], s52 offen offset:2048 nt lds
    buffer_load_dwordx4 v6, s[40:43], s52 offen offset:3072 nt lds
    s_add_u32 s52, s52, 4096
    s_and_b32 s52, s52, 0x3ffff
    s_sub_u32 s45, s45, 1
    s_cselect_b32 s42, 0, s42
    s_add_u32 s54, s54, 8192
    s_cmp_eq_u32 s54, s65
    s_cselect_b32 s54, 0, s54
    s_waitcnt vmcnt(40)
    ds_read_b128 v[208:211], v8 offset:0
    ds_read_b128 v[212:215], v9 offset:0
    ds_read_b128 v[216:219], v10 offset:0
    ds_read_b128 v[220:223], v11 offset:0
    v_mfma_f32_16x16x32_bf16 v[72:75], v[224:227], v[240:243], v[72:75]
    v_mfma_f32_16x16x32_bf16 v[76:79], v[224:227], v[244:247], v[76:79]
    v_mfma_f32_16x16x32_bf16 v[80:83], v[224:227], v[248:251], v[80:83]
    ds_read_b128 v[224:227], v8 offset:4096
    v_mfma_f32_16x16x32_bf16 v[84:87], v[228:231], v[240:243], v[84:87]
    v_mfma_f32_16x16x32_bf16 v[88:91], v[228:231], v[244:247], v[88:91]
    v_mfma_f32_16x16x32_bf16 v[92:95], v[228:231], v[248:251], v[92:95]
    ds_read_b128 v[228:231], v9 offset:4096
    v_mfma_f32_16x16x32_bf16 v[96:99], v[232:235], v[240:243], v[96:99]
    v_mfma_f32_16x16x32_bf16 v[100:103], v[232:235], v[244:247], v[100:103]
    v_mfma_f32_16x16x32_bf16 v[104:107], v[232:235], v[248:251], v[104:107]
    ds_read_b128 v[232:235], v10 offset:4096
    v_mfma_f32_16x16x32_bf16 v[108:111], v[236:239], v[240:243], v[108:111]
    v_mfma_f32_16x16x32_bf16 v[112:115], v[236:239], v[244:247], v[112:115]
    v_mfma_f32_16x16x32_bf16 v[116:119], v[236:239], v[248:251], v[116:119]
    ds_read_b128 v[236:239], v11 offset:4096
    v_mfma_f32_16x16x32_bf16 v[120:123], v[204:207], v[240:243], v[120:123]
    v_mfma_f32_16x16x32_bf16 v[124:127], v[204:207], v[244:247], v[124:127]
    v_mfma_f32_16x16x32_bf16 v[128:131], v[204:207], v[248:251], v[128:131]
    s_nop 7
    v_max3_f32 v240, v132, v133, v134
    v_max3_f32 v240, v240, v135, v144
    v_max3_f32 v240, v240, v145, v146
    v_max_f32 v240, v240, v147
    v_max3_f32 v241, v136, v137, v138
    v_max3_f32 v241, v241, v139, v148
    v_max3_f32 v241, v241, v149, v150
    v_max_f32 v241, v241, v151
    v_max3_f32 v242, v140, v141, v142
    v_max3_f32 v242, v242, v143, v152
    v_max3_f32 v242, v242, v153, v154
    v_max_f32 v242, v242, v155
    v_mov_b32 v243, v240
    v_mov_b32 v244, v241
    v_mov_b32 v245, v242
    v_permlane32_swap_b32 v240, v243
    v_permlane32_swap_b32 v241, v244
    v_permlane32_swap_b32 v242, v245
    s_nop 1
    v_max_f32 v240, v240, v243
    v_max_f32 v241, v241, v244
    v_max_f32 v242, v242, v245
    v_mov_b32 v243, v240
    v_mov_b32 v244, v241
    v_mov_b32 v245, v242
    v_permlane16_swap_b32 v240, v243
    v_permlane16_swap_b32 v241, v244
    v_permlane16_swap_b32 v242, v245
    s_nop 1
    v_max_f32 v240, v240, v243
    v_max_f32 v241, v241, v244
    v_max_f32 v242, v242, v245
    v_max_f32 v240, 0, v240
    v_exp_f32 v243, -v240
    v_max_f32 v241, 0, v241
    v_exp_f32 v244, -v241
    v_max_f32 v242, 0, v242
    v_exp_f32 v245, -v242
    v_add_f32 v20, v20, v240
    v_sub_f32 v132, v132, v240
    v_sub_f32 v133, v133, v240
    v_sub_f32 v134, v134, v240
    v_sub_f32 v135, v135, v240
    v_sub_f32 v144, v144, v240
    v_sub_f32 v145, v145, v240
    v_sub_f32 v146, v146, v240
    v_sub_f32 v147, v147, v240
    v_add_f32 v21, v21, v241
    v_sub_f32 v136, v136, v241
    v_sub_f32 v137, v137, v241
    v_sub_f32 v138, v138, v241
    v_sub_f32 v139, v139, v241
    v_sub_f32 v148, v148, v241
    v_sub_f32 v149, v149, v241
    v_sub_f32 v150, v150, v241
    v_sub_f32 v151, v151, v241
    v_add_f32 v22, v22, v242
    v_sub_f32 v140, v140, v242
    v_sub_f32 v141, v141, v242
    v_sub_f32 v142, v142, v242
    v_sub_f32 v143, v143, v242
    v_sub_f32 v152, v152, v242
    v_sub_f32 v153, v153, v242
    v_sub_f32 v154, v154, v242
    v_sub_f32 v155, v155, v242
    v_mul_f32 v24, v24, v243
    v_mul_f32 v25, v25, v243
    v_mul_f32 v26, v26, v243
    v_mul_f32 v27, v27, v243
    v_mul_f32 v36, v36, v243
    v_mul_f32 v37, v37, v243
    v_mul_f32 v38, v38, v243
    v_mul_f32 v39, v39, v243
    v_mul_f32 v48, v48, v243
    v_mul_f32 v49, v49, v243
    v_mul_f32 v50, v50, v243
    v_mul_f32 v51, v51, v243
    v_mul_f32 v60, v60, v243
    v_mul_f32 v61, v61, v243
    v_mul_f32 v62, v62, v243
    v_mul_f32 v63, v63, v243
    v_mul_f32 v72, v72, v243
    v_mul_f32 v73, v73, v243
    v_mul_f32 v74, v74, v243
    v_mul_f32 v75, v75, v243
    v_mul_f32 v84, v84, v243
    v_mul_f32 v85, v85, v243
    v_mul_f32 v86, v86, v243
    v_mul_f32 v87, v87, v243
    v_mul_f32 v96, v96, v243
    v_mul_f32 v97, v97, v243
    v_mul_f32 v98, v98, v243
    v_mul_f32 v99, v99, v243
    v_mul_f32 v108, v108, v243
    v_mul_f32 v109, v109, v243
    v_mul_f32 v110, v110, v243
    v_mul_f32 v111, v111, v243
    v_mul_f32 v120, v120, v243
    v_mul_f32 v121, v121, v243
    v_mul_f32 v122, v122, v243
    v_mul_f32 v123, v123, v243
    v_mul_f32 v28, v28, v244
    v_mul_f32 v29, v29, v244
    v_mul_f32 v30, v30, v244
    v_mul_f32 v31, v31, v244
    v_mul_f32 v40, v40, v244
    v_mul_f32 v41, v41, v244
    v_mul_f32 v42, v42, v244
    v_mul_f32 v43, v43, v244
    v_mul_f32 v52, v52, v244
    v_mul_f32 v53, v53, v244
    v_mul_f32 v54, v54, v244
    v_mul_f32 v55, v55, v244
    v_mul_f32 v64, v64, v244
    v_mul_f32 v65, v65, v244
    v_mul_f32 v66, v66, v244
    v_mul_f32 v67, v67, v244
    v_mul_f32 v76, v76, v244
    v_mul_f32 v77, v77, v244
    v_mul_f32 v78, v78, v244
    v_mul_f32 v79, v79, v244
    v_mul_f32 v88, v88, v244
    v_mul_f32 v89, v89, v244
    v_mul_f32 v90, v90, v244
    v_mul_f32 v91, v91, v244
    v_mul_f32 v100, v100, v244
    v_mul_f32 v101, v101, v244
    v_mul_f32 v102, v102, v244
    v_mul_f32 v103, v103, v244
    v_mul_f32 v112, v112, v244
    v_mul_f32 v113, v113, v244
    v_mul_f32 v114, v114, v244
    v_mul_f32 v115, v115, v244
    v_mul_f32 v124, v124, v244
    v_mul_f32 v125, v125, v244
    v_mul_f32 v126, v126, v244
    v_mul_f32 v127, v127, v244
    v_mul_f32 v32, v32, v245
    v_mul_f32 v33, v33, v245
    v_mul_f32 v34, v34, v245
    v_mul_f32 v35, v35, v245
    v_mul_f32 v44, v44, v245
    v_mul_f32 v45, v45, v245
    v_mul_f32 v46, v46, v245
    v_mul_f32 v47, v47, v245
    v_mul_f32 v56, v56, v245
    v_mul_f32 v57, v57, v245
    v_mul_f32 v58, v58, v245
    v_mul_f32 v59, v59, v245
    v_mul_f32 v68, v68, v245
    v_mul_f32 v69, v69, v245
    v_mul_f32 v70, v70, v245
    v_mul_f32 v71, v71, v245
    v_mul_f32 v80, v80, v245
    v_mul_f32 v81, v81, v245
    v_mul_f32 v82, v82, v245
    v_mul_f32 v83, v83, v245
    v_mul_f32 v92, v92, v245
    v_mul_f32 v93, v93, v245
    v_mul_f32 v94, v94, v245
    v_mul_f32 v95, v95, v245
    v_mul_f32 v104, v104, v245
    v_mul_f32 v105, v105, v245
    v_mul_f32 v106, v106, v245
    v_mul_f32 v107, v107, v245
    v_mul_f32 v116, v116, v245
    v_mul_f32 v117, v117, v245
    v_mul_f32 v118, v118, v245
    v_mul_f32 v119, v119, v245
    v_mul_f32 v128, v128, v245
    v_mul_f32 v129, v129, v245
    v_mul_f32 v130, v130, v245
    v_mul_f32 v131, v131, v245
    v_exp_f32 v132, v132
    v_exp_f32 v133, v133
    v_exp_f32 v134, v134
    v_exp_f32 v135, v135
    v_exp_f32 v136, v136
    v_exp_f32 v137, v137
    v_exp_f32 v138, v138
    v_exp_f32 v139, v139
    v_exp_f32 v140, v140
    v_exp_f32 v141, v141
    v_exp_f32 v142, v142
    v_exp_f32 v143, v143
    s_branch L_join_B1
L_rare_B2:
    s_cmp_eq_u32 s66, 0
    s_cbranch_scc1 L_th_33
    s_waitcnt vmcnt(6)
L_th_33:
    s_add_u32 m0, s54, s56
    s_nop 0
    buffer_load_dwordx4 v5, s[40:43], s52 offen offset:0 nt lds
    buffer_load_dwordx4 v6, s[40:43], s52 offen offset:1024 nt lds
    buffer_load_dwordx4 v5, s[40:43], s52 offen offset:2048 nt lds
    buffer_load_dwordx4 v6, s[40:43], s52 offen offset:3072 nt lds
    v_mfma_f32_16x16x32_bf16 v[60:63], v[220:223], v[240:243], v[60:63]
    v_add_u32 v16, s60, v16
    v_mfma_f32_16x16x32_bf16 v[64:67], v[220:223], v[244:247], v[64:67]
    v_add_u32 v17, s60, v17
    v_mfma_f32_16x16x32_bf16 v[68:71], v[220:223], v[248:251], v[68:71]
    v_add_u32 v18, s60, v18
    v_add_u32 v19, s60, v19
    s_add_u32 m0, m0, 4096
    s_add_u32 s52, s52, 4096
    buffer_load_dwordx4 v5, s[40:43], s52 offen offset:0 nt lds
    buffer_load_dwordx4 v6, s[40:43], s52 offen offset:1024 nt lds
    buffer_load_dwordx4 v5, s[40:43], s52 offen offset:2048 nt lds
    buffer_load_dwordx4 v6, s[40:43], s52 offen offset:3072 nt lds
    s_add_u32 s52, s52, 4096
    s_and_b32 s52, s52, 0x3ffff
    s_sub_u32 s45, s45, 1
    s_cselect_b32 s42, 0, s42
    s_add_u32 s54, s54, 8192
    s_cmp_eq_u32 s54, s65
    s_cselect_b32 s54, 0, s54
    s_waitcnt vmcnt(40)
    v_mfma_f32_16x16x32_bf16 v[72:75], v[224:227], v[240:243], v[72:75]
    v_mfma_f32_16x16x32_bf16 v[76:79], v[224:227], v[244:247], v[76:79]
    v_mfma_f32_16x16x32_bf16 v[80:83], v[224:227], v[248:251], v[80:83]
    v_mfma_f32_16x16x32_bf16 v[84:87], v[228:231], v[240:243], v[84:87]
    v_mfma_f32_16x16x32_bf16 v[88:91], v[228:231], v[244:247], v[88:91]
    v_mfma_f32_16x16x32_bf16 v[92:95], v[228:231], v[248:251], v[92:95]
    v_mfma_f32_16x16x32_bf16 v[96:99], v[232:235], v[240:243], v[96:99]
    v_mfma_f32_16x16x32_bf16 v[100:103], v[232:235], v[244:247], v[100:103]
    v_mfma_f32_16x16x32_bf16 v[104:107], v[232:235], v[248:251], v[104:107]
    v_mfma_f32_16x16x32_bf16 v[108:111], v[236:239], v[240:243], v[108:111]
    v_mfma_f32_16x16x32_bf16 v[112:115], v[236:239], v[244:247], v[112:115]
    v_mfma_f32_16x16x32_bf16 v[116:119], v[236:239], v[248:251], v[116:119]
    v_mfma_f32_16x16x32_bf16 v[120:123], v[204:207], v[240:243], v[120:123]
    v_mfma_f32_16x16x32_bf16 v[124:127], v[204:207], v[244:247], v[124:127]
    v_mfma_f32_16x16x32_bf16 v[128:131], v[204:207], v[248:251], v[128:131]
    s_nop 7
    v_max3_f32 v240, v132, v133, v134
    v_max3_f32 v240, v240, v135, v144
    v_max3_f32 v240, v240, v145, v146
    v_max_f32 v240, v240, v147
    v_max3_f32 v241, v136, v137, v138
    v_max3_f32 v241, v241, v139, v148
    v_max3_f32 v241, v241, v149, v150
    v_max_f32 v241, v241, v151
    v_max3_f32 v242, v140, v141, v142
    v_max3_f32 v242, v242, v143, v152
    v_max3_f32 v242, v242, v153, v154
    v_max_f32 v242, v242, v155
    v_mov_b32 v243, v240
    v_mov_b32 v244, v241
    v_mov_b32 v245, v242
    v_permlane32_swap_b32 v240, v243
    v_permlane32_swap_b32 v241, v244
    v_permlane32_swap_b32 v242, v245
    s_nop 1
    v_max_f32 v240, v240, v243
    v_max_f32 v241, v241, v244
    v_max_f32 v242, v242, v245
    v_mov_b32 v243, v240
    v_mov_b32 v244, v241
    v_mov_b32 v245, v242
    v_permlane16_swap_b32 v240, v243
    v_permlane16_swap_b32 v241, v244
    v_permlane16_swap_b32 v242, v245
    s_nop 1
    v_max_f32 v240, v240, v243
    v_max_f32 v241, v241, v244
    v_max_f32 v242, v242, v245
    v_max_f32 v240, 0, v240
    v_exp_f32 v243, -v240
    v_max_f32 v241, 0, v241
    v_exp_f32 v244, -v241
    v_max_f32 v242, 0, v242
    v_exp_f32 v245, -v242
    v_add_f32 v20, v20, v240
    v_sub_f32 v132, v132, v240
    v_sub_f32 v133, v133, v240
    v_sub_f32 v134, v134, v240
    v_sub_f32 v135, v135, v240
    v_sub_f32 v144, v144, v240
    v_sub_f32 v145, v145, v240
    v_sub_f32 v146, v146, v240
    v_sub_f32 v147, v147, v240
    v_add_f32 v21, v21, v241
    v_sub_f32 v136, v136, v241
    v_sub_f32 v137, v137, v241
    v_sub_f32 v138, v138, v241
    v_sub_f32 v139, v139, v241
    v_sub_f32 v148, v148, v241
    v_sub_f32 v149, v149, v241
    v_sub_f32 v150, v150, v241
    v_sub_f32 v151, v151, v241
    v_add_f32 v22, v22, v242
    v_sub_f32 v140, v140, v242
    v_sub_f32 v141, v141, v242
    v_sub_f32 v142, v142, v242
    v_sub_f32 v143, v143, v242
    v_sub_f32 v152, v152, v242
    v_sub_f32 v153, v153, v242
    v_sub_f32 v154, v154, v242
    v_sub_f32 v155, v155, v242
    v_mul_f32 v24, v24, v243
    v_mul_f32 v25, v25, v243
    v_mul_f32 v26, v26, v243
    v_mul_f32 v27, v27, v243
    v_mul_f32 v36, v36, v243
    v_mul_f32 v37, v37, v243
    v_mul_f32 v38, v38, v243
    v_mul_f32 v39, v39, v243
    v_mul_f32 v48, v48, v243
    v_mul_f32 v49, v49, v243
    v_mul_f32 v50, v50, v243
    v_mul_f32 v51, v51, v243
    v_mul_f32 v60, v60, v243
    v_mul_f32 v61, v61, v243
    v_mul_f32 v62, v62, v243
    v_mul_f32 v63, v63, v243
    v_mul_f32 v72, v72, v243
    v_mul_f32 v73, v73, v243
    v_mul_f32 v74, v74, v243
    v_mul_f32 v75, v75, v243
    v_mul_f32 v84, v84, v243
    v_mul_f32 v85, v85, v243
    v_mul_f32 v86, v86, v243
    v_mul_f32 v87, v87, v243
    v_mul_f32 v96, v96, v243
    v_mul_f32 v97, v97, v243
    v_mul_f32 v98, v98, v243
    v_mul_f32 v99, v99, v243
    v_mul_f32 v108, v108, v243
    v_mul_f32 v109, v109, v243
    v_mul_f32 v110, v110, v243
    v_mul_f32 v111, v111, v243
    v_mul_f32 v120, v120, v243
    v_mul_f32 v121, v121, v243
    v_mul_f32 v122, v122, v243
    v_mul_f32 v123, v123, v243
    v_mul_f32 v28, v28, v244
    v_mul_f32 v29, v29, v244
    v_mul_f32 v30, v30, v244
    v_mul_f32 v31, v31, v244
    v_mul_f32 v40, v40, v244
    v_mul_f32 v41, v41, v244
    v_mul_f32 v42, v42, v244
    v_mul_f32 v43, v43, v244
    v_mul_f32 v52, v52, v244
    v_mul_f32 v53, v53, v244
    v_mul_f32 v54, v54, v244
    v_mul_f32 v55, v55, v244
    v_mul_f32 v64, v64, v244
    v_mul_f32 v65, v65, v244
    v_mul_f32 v66, v66, v244
    v_mul_f32 v67, v67, v244
    v_mul_f32 v76, v76, v244
    v_mul_f32 v77, v77, v244
    v_mul_f32 v78, v78, v244
    v_mul_f32 v79, v79, v244
    v_mul_f32 v88, v88, v244
    v_mul_f32 v89, v89, v244
    v_mul_f32 v90, v90, v244
    v_mul_f32 v91, v91, v244
    v_mul_f32 v100, v100, v244
    v_mul_f32 v101, v101, v244
    v_mul_f32 v102, v102, v244
    v_mul_f32 v103, v103, v244
    v_mul_f32 v112, v112, v244
    v_mul_f32 v113, v113, v244
    v_mul_f32 v114, v114, v244
    v_mul_f32 v115, v115, v244
    v_mul_f32 v124, v124, v244
    v_mul_f32 v125, v125, v244
    v_mul_f32 v126, v126, v244
    v_mul_f32 v127, v127, v244
    v_mul_f32 v32, v32, v245
    v_mul_f32 v33, v33, v245
    v_mul_f32 v34, v34, v245
    v_mul_f32 v35, v35, v245
    v_mul_f32 v44, v44, v245
    v_mul_f32 v45, v45, v245
    v_mul_f32 v46, v46, v245
    v_mul_f32 v47, v47, v245
    v_mul_f32 v56, v56, v245
    v_mul_f32 v57, v57, v245
    v_mul_f32 v58, v58, v245
    v_mul_f32 v59, v59, v245
    v_mul_f32 v68, v68, v245
    v_mul_f32 v69, v69, v245
    v_mul_f32 v70, v70, v245
    v_mul_f32 v71, v71, v245
    v_mul_f32 v80, v80, v245
    v_mul_f32 v81, v81, v245
    v_mul_f32 v82, v82, v245
    v_mul_f32 v83, v83, v245
    v_mul_f32 v92, v92, v245
    v_mul_f32 v93, v93, v245
    v_mul_f32 v94, v94, v245
    v_mul_f32 v95, v95, v245
    v_mul_f32 v104, v104, v245
    v_mul_f32 v105, v105, v245
    v_mul_f32 v106, v106, v245
    v_mul_f32 v107, v107, v245
    v_mul_f32 v116, v116, v245
    v_mul_f32 v117, v117, v245
    v_mul_f32 v118, v118, v245
    v_mul_f32 v119, v119, v245
    v_mul_f32 v128, v128, v245
    v_mul_f32 v129, v129, v245
    v_mul_f32 v130, v130, v245
    v_mul_f32 v131, v131, v245
    v_exp_f32 v132, v132
    v_exp_f32 v133, v133
    v_exp_f32 v134, v134
    v_exp_f32 v135, v135
    v_exp_f32 v136, v136
    v_exp_f32 v137, v137
    v_exp_f32 v138, v138
    v_exp_f32 v139, v139
    v_exp_f32 v140, v140
    v_exp_f32 v141, v141
    v_exp_f32 v142, v142
    v_exp_f32 v143, v143
    s_branch L_join_B2
L_rare_A1:
    v_mfma_f32_16x16x32_bf16 v[60:63], v[220:223], v[240:243], v[60:63]
    v_add_u32 v16, s60, v16
    v_mfma_f32_16x16x32_bf16 v[64:67], v[220:223], v[244:247], v[64:67]
    v_add_u32 v17, s60, v17
    v_mfma_f32_16x16x32_bf16 v[68:71], v[220:223], v[248:251], v[68:71]
    v_add_u32 v18, s60, v18
    v_add_u32 v19, s60, v19
L_p_34:
    ds_read_b32 v3, v2 offset:12
    s_waitcnt lgkmcnt(0)
    v_readfirstlane_b32 s31, v3
    s_cmp_ge_u32 s31, s61
    s_cbranch_scc1 L_q_35
    s_branch L_p_34
L_q_35:
    ds_read_b128 v[208:211], v8 offset:0
    ds_read_b128 v[212:215], v9 offset:0
    ds_read_b128 v[216:219], v10 offset:0
    ds_read_b128 v[220:223], v11 offset:0
    v_mfma_f32_16x16x32_bf16 v[72:75], v[224:227], v[240:243], v[72:75]
    v_mfma_f32_16x16x32_bf16 v[76:79], v[224:227], v[244:247], v[76:79]
    v_mfma_f32_16x16x32_bf16 v[80:83], v[224:227], v[248:251], v[80:83]
    ds_read_b128 v[224:227], v8 offset:4096
    s_add_u32 m0, s53, s55
    s_nop 0
    buffer_load_dwordx4 v5, s[36:39], s51 offen offset:0 lds
    buffer_load_dwordx4 v6, s[36:39], s51 offen offset:1024 lds
    v_mfma_f32_16x16x32_bf16 v[84:87], v[228:231], v[240:243], v[84:87]
    v_mfma_f32_16x16x32_bf16 v[88:91], v[228:231], v[244:247], v[88:91]
    v_mfma_f32_16x16x32_bf16 v[92:95], v[228:231], v[248:251], v[92:95]
    ds_read_b128 v[228:231], v9 offset:4096
    buffer_load_dwordx4 v5, s[36:39], s51 offen offset:2048 lds
    buffer_load_dwordx4 v6, s[36:39], s51 offen offset:3072 lds
    v_mfma_f32_16x16x32_bf16 v[96:99], v[232:235], v[240:243], v[96:99]
    v_mfma_f32_16x16x32_bf16 v[100:103], v[232:235], v[244:247], v[100:103]
    v_mfma_f32_16x16x32_bf16 v[104:107], v[232:235], v[248:251], v[104:107]
    ds_read_b128 v[232:235], v10 offset:4096
    s_add_u32 m0, m0, 4096
    s_add_u32 s51, s51, 4096
    buffer_load_dwordx4 v5, s[36:39], s51 offen offset:0 lds
    buffer_load_dwordx4 v6, s[36:39], s51 offen offset:1024 lds
    v_mfma_f32_16x16x32_bf16 v[108:111], v[236:239], v[240:243], v[108:111]
    v_mfma_f32_16x16x32_bf16 v[112:115], v[236:239], v[244:247], v[112:115]
    v_mfma_f32_16x16x32_bf16 v[116:119], v[236:239], v[248:251], v[116:119]
    ds_read_b128 v[236:239], v11 offset:4096
    buffer_load_dwordx4 v5, s[36:39], s51 offen offset:2048 lds
    buffer_load_dwordx4 v6, s[36:39], s51 offen offset:3072 lds
    v_mfma_f32_16x16x32_bf16 v[120:123], v[204:207], v[240:243], v[120:123]
    v_mfma_f32_16x16x32_bf16 v[124:127], v[204:207], v[244:247], v[124:127]
    v_mfma_f32_16x16x32_bf16 v[128:131], v[204:207], v[248:251], v[128:131]
    s_add_u32 s51, s51, 4096
    s_and_b32 s51, s51, 0x3ffff
    s_sub_u32 s44, s44, 1
    s_cselect_b32 s38, 0, s38
    s_add_u32 s53, s53, 8192
    s_cmp_eq_u32 s53, s64
    s_cselect_b32 s53, 0, s53
    s_nop 7
    v_max3_f32 v240, v132, v133, v134
    v_max3_f32 v240, v240, v135, v144
    v_max3_f32 v240, v240, v145, v146
    v_max_f32 v240, v240, v147
    v_max3_f32 v241, v136, v137, v138
    v_max3_f32 v241, v241, v139, v148
    v_max3_f32 v241, v241, v149, v150
    v_max_f32 v241, v241, v151
    v_max3_f32 v242, v140, v141, v142
    v_max3_f32 v242, v242, v143, v152
    v_max3_f32 v242, v242, v153, v154
    v_max_f32 v242, v242, v155
    v_mov_b32 v243, v240
    v_mov_b32 v244, v241
    v_mov_b32 v245, v242
    v_permlane32_swap_b32 v240, v243
    v_permlane32_swap_b32 v241, v244
    v_permlane32_swap_b32 v242, v245
    s_nop 1
    v_max_f32 v240, v240, v243
    v_max_f32 v241, v241, v244
    v_max_f32 v242, v242, v245
    v_mov_b32 v243, v240
    v_mov_b32 v244, v241
    v_mov_b32 v245, v242
    v_permlane16_swap_b32 v240, v243
    v_permlane16_swap_b32 v241, v244
    v_permlane16_swap_b32 v242, v245
    s_nop 1
    v_max_f32 v240, v240, v243
    v_max_f32 v241, v241, v244
    v_max_f32 v242, v242, v245
    v_max_f32 v240, 0, v240
    v_exp_f32 v243, -v240
    v_max_f32 v241, 0, v241
    v_exp_f32 v244, -v241
    v_max_f32 v242, 0, v242
    v_exp_f32 v245, -v242
    v_add_f32 v20, v20, v240
    v_sub_f32 v132, v132, v240
    v_sub_f32 v133, v133, v240
    v_sub_f32 v134, v134, v240
    v_sub_f32 v135, v135, v240
    v_sub_f32 v144, v144, v240
    v_sub_f32 v145, v145, v240
    v_sub_f32 v146, v146, v240
    v_sub_f32 v147, v147, v240
    v_add_f32 v21, v21, v241
    v_sub_f32 v136, v136, v241
    v_sub_f32 v137, v137, v241
    v_sub_f32 v138, v138, v241
    v_sub_f32 v139, v139, v241
    v_sub_f32 v148, v148, v241
    v_sub_f32 v149, v149, v241
    v_sub_f32 v150, v150, v241
    v_sub_f32 v151, v151, v241
    v_add_f32 v22, v22, v242
    v_sub_f32 v140, v140, v242
    v_sub_f32 v141, v141, v242
    v_sub_f32 v142, v142, v242
    v_sub_f32 v143, v143, v242
    v_sub_f32 v152, v152, v242
    v_sub_f32 v153, v153, v242
    v_sub_f32 v154, v154, v242
    v_sub_f32 v155, v155, v242
    v_mul_f32 v24, v24, v243
    v_mul_f32 v25, v25, v243
    v_mul_f32 v26, v26, v243
    v_mul_f32 v27, v27, v243
    v_mul_f32 v36, v36, v243
    v_mul_f32 v37, v37, v243
    v_mul_f32 v38, v38, v243
    v_mul_f32 v39, v39, v243
    v_mul_f32 v48, v48, v243
    v_mul_f32 v49, v49, v243
    v_mul_f32 v50, v50, v243
    v_mul_f32 v51, v51, v243
    v_mul_f32 v60, v60, v243
    v_mul_f32 v61, v61, v243
    v_mul_f32 v62, v62, v243
    v_mul_f32 v63, v63, v243
    v_mul_f32 v72, v72, v243
    v_mul_f32 v73, v73, v243
    v_mul_f32 v74, v74, v243
    v_mul_f32 v75, v75, v243
    v_mul_f32 v84, v84, v243
    v_mul_f32 v85, v85, v243
    v_mul_f32 v86, v86, v243
    v_mul_f32 v87, v87, v243
    v_mul_f32 v96, v96, v243
    v_mul_f32 v97, v97, v243
    v_mul_f32 v98, v98, v243
    v_mul_f32 v99, v99, v243
    v_mul_f32 v108, v108, v243
    v_mul_f32 v109, v109, v243
    v_mul_f32 v110, v110, v243
    v_mul_f32 v111, v111, v243
    v_mul_f32 v120, v120, v243
    v_mul_f32 v121, v121, v243
    v_mul_f32 v122, v122, v243
    v_mul_f32 v123, v123, v243
    v_mul_f32 v28, v28, v244
    v_mul_f32 v29, v29, v244
    v_mul_f32 v30, v30, v244
    v_mul_f32 v31, v31, v244
    v_mul_f32 v40, v40, v244
    v_mul_f32 v41, v41, v244
    v_mul_f32 v42, v42, v244
    v_mul_f32 v43, v43, v244
    v_mul_f32 v52, v52, v244
    v_mul_f32 v53, v53, v244
    v_mul_f32 v54, v54, v244
    v_mul_f32 v55, v55, v244
    v_mul_f32 v64, v64, v244
    v_mul_f32 v65, v65, v244
    v_mul_f32 v66, v66, v244
    v_mul_f32 v67, v67, v244
    v_mul_f32 v76, v76, v244
    v_mul_f32 v77, v77, v244
    v_mul_f32 v78, v78, v244
    v_mul_f32 v79, v79, v244
    v_mul_f32 v88, v88, v244
    v_mul_f32 v89, v89, v244
    v_mul_f32 v90, v90, v244
    v_mul_f32 v91, v91, v244
    v_mul_f32 v100, v100, v244
    v_mul_f32 v101, v101, v244
    v_mul_f32 v102, v102, v244
    v_mul_f32 v103, v103, v244
    v_mul_f32 v112, v112, v244
    v_mul_f32 v113, v113, v244
    v_mul_f32 v114, v114, v244
    v_mul_f32 v115, v115, v244
    v_mul_f32 v124, v124, v244
    v_mul_f32 v125, v125, v244
    v_mul_f32 v126, v126, v244
    v_mul_f32 v127, v127, v244
    v_mul_f32 v32, v32, v245
    v_mul_f32 v33, v33, v245
    v_mul_f32 v34, v34, v245
    v_mul_f32 v35, v35, v245
    v_mul_f32 v44, v44, v245
    v_mul_f32 v45, v45, v245
    v_mul_f32 v46, v46, v245
    v_mul_f32 v47, v47, v245
    v_mul_f32 v56, v56, v245
    v_mul_f32 v57, v57, v245
    v_mul_f32 v58, v58, v245
    v_mul_f32 v59, v59, v245
    v_mul_f32 v68, v68, v245
    v_mul_f32 v69, v69, v245
    v_mul_f32 v70, v70, v245
    v_mul_f32 v71, v71, v245
    v_mul_f32 v80, v80, v245
    v_mul_f32 v81, v81, v245
    v_mul_f32 v82, v82, v245
    v_mul_f32 v83, v83, v245
    v_mul_f32 v92, v92, v245
    v_mul_f32 v93, v93, v245
    v_mul_f32 v94, v94, v245
    v_mul_f32 v95, v95, v245
    v_mul_f32 v104, v104, v245
    v_mul_f32 v105, v105, v245
    v_mul_f32 v106, v106, v245
    v_mul_f32 v107, v107, v245
    v_mul_f32 v116, v116, v245
    v_mul_f32 v117, v117, v245
    v_mul_f32 v118, v118, v245
    v_mul_f32 v119, v119, v245
    v_mul_f32 v128, v128, v245
    v_mul_f32 v129, v129, v245
    v_mul_f32 v130, v130, v245
    v_mul_f32 v131, v131, v245
    v_exp_f32 v132, v132
    v_exp_f32 v133, v133
    v_exp_f32 v134, v134
    v_exp_f32 v135, v135
    v_exp_f32 v136, v136
    v_exp_f32 v137, v137
    v_exp_f32 v138, v138
    v_exp_f32 v139, v139
    v_exp_f32 v140, v140
    v_exp_f32 v141, v141
    v_exp_f32 v142, v142
    v_exp_f32 v143, v143
    s_branch L_join_A1
L_rare_A2:
    v_mfma_f32_16x16x32_bf16 v[60:63], v[220:223], v[240:243], v[60:63]
    v_add_u32 v16, s60, v16
    v_mfma_f32_16x16x32_bf16 v[64:67], v[220:223], v[244:247], v[64:67]
    v_add_u32 v17, s60, v17
    v_mfma_f32_16x16x32_bf16 v[68:71], v[220:223], v[248:251], v[68:71]
    v_add_u32 v18, s60, v18
    v_add_u32 v19, s60, v19
L_p_36:
    ds_read_b32 v3, v2 offset:12
    s_waitcnt lgkmcnt(0)
    v_readfirstlane_b32 s31, v3
    s_cmp_ge_u32 s31, s61
    s_cbranch_scc1 L_q_37
    s_branch L_p_36
L_q_37:
    v_mfma_f32_16x16x32_bf16 v[72:75], v[224:227], v[240:243], v[72:75]
    v_mfma_f32_16x16x32_bf16 v[76:79], v[224:227], v[244:247], v[76:79]
    v_mfma_f32_16x16x32_bf16 v[80:83], v[224:227], v[248:251], v[80:83]
    s_add_u32 m0, s53, s55
    s_nop 0
    buffer_load_dwordx4 v5, s[36:39], s51 offen offset:0 lds
    buffer_load_dwordx4 v6, s[36:39], s51 offen offset:1024 lds
    v_mfma_f32_16x16x32_bf16 v[84:87], v[228:231], v[240:243], v[84:87]
    v_mfma_f32_16x16x32_bf16 v[88:91], v[228:231], v[244:247], v[88:91]
    v_mfma_f32_16x16x32_bf16 v[92:95], v[228:231], v[248:251], v[92:95]
    buffer_load_dwordx4 v5, s[36:39], s51 offen offset:2048 lds
    buffer_load_dwordx4 v6, s[36:39], s51 offen offset:3072 lds
    v_mfma_f32_16x16x32_bf16 v[96:99], v[232:235], v[240:243], v[96:99]
    v_mfma_f32_16x16x32_bf16 v[100:103], v[232:235], v[244:247], v[100:103]
    v_mfma_f32_16x16x32_bf16 v[104:107], v[232:235], v[248:251], v[104:107]
    s_add_u32 m0, m0, 4096
    s_add_u32 s51, s51, 4096
    buffer_load_dwordx4 v5, s[36:39], s51 offen offset:0 lds
    buffer_load_dwordx4 v6, s[36:39], s51 offen offset:1024 lds
    v_mfma_f32_16x16x32_bf16 v[108:111], v[236:239], v[240:243], v[108:111]
    v_mfma_f32_16x16x32_bf16 v[112:115], v[236:239], v[244:247], v[112:115]
    v_mfma_f32_16x16x32_bf16 v[116:119], v[236:239], v[248:251], v[116:119]
    buffer_load_dwordx4 v5, s[36:39], s51 offen offset:2048 lds
    buffer_load_dwordx4 v6, s[36:39], s51 offen offset:3072 lds
    v_mfma_f32_16x16x32_bf16 v[120:123], v[204:207], v[240:243], v[120:123]
    v_mfma_f32_16x16x32_bf16 v[124:127], v[204:207], v[244:247], v[124:127]
    v_mfma_f32_16x16x32_bf16 v[128:131], v[204:207], v[248:251], v[128:131]
    s_add_u32 s51, s51, 4096
    s_and_b32 s51, s51, 0x3ffff
    s_sub_u32 s44, s44, 1
    s_cselect_b32 s38, 0, s38
    s_add_u32 s53, s53, 8192
    s_cmp_eq_u32 s53, s64
    s_cselect_b32 s53, 0, s53
    s_nop 7
    v_max3_f32 v240, v132, v133, v134
    v_max3_f32 v240, v240, v135, v144
    v_max3_f32 v240, v240, v145, v146
    v_max_f32 v240, v240, v147
    v_max3_f32 v241, v136, v137, v138
    v_max3_f32 v241, v241, v139, v148
    v_max3_f32 v241, v241, v149, v150
    v_max_f32 v241, v241, v151
    v_max3_f32 v242, v140, v141, v142
    v_max3_f32 v242, v242, v143, v152
    v_max3_f32 v242, v242, v153, v154
    v_max_f32 v242, v242, v155
    v_mov_b32 v243, v240
    v_mov_b32 v244, v241
    v_mov_b32 v245, v242
    v_permlane32_swap_b32 v240, v243
    v_permlane32_swap_b32 v241, v244
    v_permlane32_swap_b32 v242, v245
    s_nop 1
    v_max_f32 v240, v240, v243
    v_max_f32 v241, v241, v244
    v_max_f32 v242, v242, v245
    v_mov_b32 v243, v240
    v_mov_b32 v244, v241
    v_mov_b32 v245, v242
    v_permlane16_swap_b32 v240, v243
    v_permlane16_swap_b32 v241, v244
    v_permlane16_swap_b32 v242, v245
    s_nop 1
    v_max_f32 v240, v240, v243
    v_max_f32 v241, v241, v244
    v_max_f32 v242, v242, v245
    v_max_f32 v240, 0, v240
    v_exp_f32 v243, -v240
    v_max_f32 v241, 0, v241
    v_exp_f32 v244, -v241
    v_max_f32 v242, 0, v242
    v_exp_f32 v245, -v242
    v_add_f32 v20, v20, v240
    v_sub_f32 v132, v132, v240
    v_sub_f32 v133, v133, v240
    v_sub_f32 v134, v134, v240
    v_sub_f32 v135, v135, v240
    v_sub_f32 v144, v144, v240
    v_sub_f32 v145, v145, v240
    v_sub_f32 v146, v146, v240
    v_sub_f32 v147, v147, v240
    v_add_f32 v21, v21, v241
    v_sub_f32 v136, v136, v241
    v_sub_f32 v137, v137, v241
    v_sub_f32 v138, v138, v241
    v_sub_f32 v139, v139, v241
    v_sub_f32 v148, v148, v241
    v_sub_f32 v149, v149, v241
    v_sub_f32 v150, v150, v241
    v_sub_f32 v151, v151, v241
    v_add_f32 v22, v22, v242
    v_sub_f32 v140, v140, v242
    v_sub_f32 v141, v141, v242
    v_sub_f32 v142, v142, v242
    v_sub_f32 v143, v143, v242
    v_sub_f32 v152, v152, v242
    v_sub_f32 v153, v153, v242
    v_sub_f32 v154, v154, v242
    v_sub_f32 v155, v155, v242
    v_mul_f32 v24, v24, v243
    v_mul_f32 v25, v25, v243
    v_mul_f32 v26, v26, v243
    v_mul_f32 v27, v27, v243
    v_mul_f32 v36, v36, v243
    v_mul_f32 v37, v37, v243
    v_mul_f32 v38, v38, v243
    v_mul_f32 v39, v39, v243
    v_mul_f32 v48, v48, v243
    v_mul_f32 v49, v49, v243
    v_mul_f32 v50, v50, v243
    v_mul_f32 v51, v51, v243
    v_mul_f32 v60, v60, v243
    v_mul_f32 v61, v61, v243
    v_mul_f32 v62, v62, v243
    v_mul_f32 v63, v63, v243
    v_mul_f32 v72, v72, v243
    v_mul_f32 v73, v73, v243
    v_mul_f32 v74, v74, v243
    v_mul_f32 v75, v75, v243
    v_mul_f32 v84, v84, v243
    v_mul_f32 v85, v85, v243
    v_mul_f32 v86, v86, v243
    v_mul_f32 v87, v87, v243
    v_mul_f32 v96, v96, v243
    v_mul_f32 v97, v97, v243
    v_mul_f32 v98, v98, v243
    v_mul_f32 v99, v99, v243
    v_mul_f32 v108, v108, v243
    v_mul_f32 v109, v109, v243
    v_mul_f32 v110, v110, v243
    v_mul_f32 v111, v111, v243
    v_mul_f32 v120, v120, v243
    v_mul_f32 v121, v121, v243
    v_mul_f32 v122, v122, v243
    v_mul_f32 v123, v123, v243
    v_mul_f32 v28, v28, v244
    v_mul_f32 v29, v29, v244
    v_mul_f32 v30, v30, v244
    v_mul_f32 v31, v31, v244
    v_mul_f32 v40, v40, v244
    v_mul_f32 v41, v41, v244
    v_mul_f32 v42, v42, v244
    v_mul_f32 v43, v43, v244
    v_mul_f32 v52, v52, v244
    v_mul_f32 v53, v53, v244
    v_mul_f32 v54, v54, v244
    v_mul_f32 v55, v55, v244
    v_mul_f32 v64, v64, v244
    v_mul_f32 v65, v65, v244
    v_mul_f32 v66, v66, v244
    v_mul_f32 v67, v67, v244
    v_mul_f32 v76, v76, v244
    v_mul_f32 v77, v77, v244
    v_mul_f32 v78, v78, v244
    v_mul_f32 v79, v79, v244
    v_mul_f32 v88, v88, v244
    v_mul_f32 v89, v89, v244
    v_mul_f32 v90, v90, v244
    v_mul_f32 v91, v91, v244
    v_mul_f32 v100, v100, v244
    v_mul_f32 v101, v101, v244
    v_mul_f32 v102, v102, v244
    v_mul_f32 v103, v103, v244
    v_mul_f32 v112, v112, v244
    v_mul_f32 v113, v113, v244
    v_mul_f32 v114, v114, v244
    v_mul_f32 v115, v115, v244
    v_mul_f32 v124, v124, v244
    v_mul_f32 v125, v125, v244
    v_mul_f32 v126, v126, v244
    v_mul_f32 v127, v127, v244
    v_mul_f32 v32, v32, v245
    v_mul_f32 v33, v33, v245
    v_mul_f32 v34, v34, v245
    v_mul_f32 v35, v35, v245
    v_mul_f32 v44, v44, v245
    v_mul_f32 v45, v45, v245
    v_mul_f32 v46, v46, v245
    v_mul_f32 v47, v47, v245
    v_mul_f32 v56, v56, v245
    v_mul_f32 v57, v57, v245
    v_mul_f32 v58, v58, v245
    v_mul_f32 v59, v59, v245
    v_mul_f32 v68, v68, v245
    v_mul_f32 v69, v69, v245
    v_mul_f32 v70, v70, v245
    v_mul_f32 v71, v71, v245
    v_mul_f32 v80, v80, v245
    v_mul_f32 v81, v81, v245
    v_mul_f32 v82, v82, v245
    v_mul_f32 v83, v83, v245
    v_mul_f32 v92, v92, v245
    v_mul_f32 v93, v93, v245
    v_mul_f32 v94, v94, v245
    v_mul_f32 v95, v95, v245
    v_mul_f32 v104, v104, v245
    v_mul_f32 v105, v105, v245
    v_mul_f32 v106, v106, v245
    v_mul_f32 v107, v107, v245
    v_mul_f32 v116, v116, v245
    v_mul_f32 v117, v117, v245
    v_mul_f32 v118, v118, v245
    v_mul_f32 v119, v119, v245
    v_mul_f32 v128, v128, v245
    v_mul_f32 v129, v129, v245
    v_mul_f32 v130, v130, v245
    v_mul_f32 v131, v131, v245
    v_exp_f32 v132, v132
    v_exp_f32 v133, v133
    v_exp_f32 v134, v134
    v_exp_f32 v135, v135
    v_exp_f32 v136, v136
    v_exp_f32 v137, v137
    v_exp_f32 v138, v138
    v_exp_f32 v139, v139
    v_exp_f32 v140, v140
    v_exp_f32 v141, v141
    v_exp_f32 v142, v142
    v_exp_f32 v143, v143
    s_branch L_join_A2
K_end:
    s_waitcnt vmcnt(0)
    s_endpgm
K_last:
.section .rodata,"a"
.p2align 6
.amdhsa_kernel concat_heads__gqa_block_cached__mha_block_cached__near_ridge_kernel
  .amdhsa_next_free_vgpr 256
  .amdhsa_next_free_sgpr 102
  .amdhsa_accum_offset 256
  .amdhsa_group_segment_fixed_size 0
  .amdhsa_kernarg_size 104
  .amdhsa_user_sgpr_count 2
  .amdhsa_user_sgpr_kernarg_segment_ptr 1
  .amdhsa_system_sgpr_workgroup_id_x 1
.end_amdhsa_kernel
```
